```python
import torch

def _softmax(x, axis=-1):
    return torch.softmax(x, dim=axis)
def _gelu(x):
    return torch.nn.functional.gelu(x, approximate="tanh")
def _silu(x):
    return torch.nn.functional.silu(x)
def _sigmoid(x):
    return torch.sigmoid(x)
def _layernorm(x, axis=-1, eps=1e-5):
    m = x.mean(dim=axis, keepdim=True)
    v = x.var(dim=axis, keepdim=True, unbiased=False)
    return (x - m) / torch.sqrt(v + eps)
def _scatter_add(tgt, idx, src, axis=0):
    return tgt.clone().index_add_(axis, idx, src)
def _segment_sum(src, seg, n):
    out = torch.zeros((n,) + src.shape[1:], dtype=src.dtype)
    return out.index_add_(0, seg, src)
def _pad(x, pw):
    flat = tuple(v for pair in reversed(pw) for v in pair)
    return torch.nn.functional.pad(x, flat)

kernel_name = 'standalone__mha_softmax__near_ridge'

def setup_inputs():

    _w = (lambda a: (lambda t: t.to(torch.bfloat16) if t.is_floating_point() else t)(torch.as_tensor(a)))
    B, H, Sq, Sk, D = 16, 32, 256, 256, 128
    return {
        "q": _w((lambda *s: torch.randn(*s, dtype=torch.bfloat16) * 0.8)(B, H, Sq, D)),
        "k": _w((lambda *s: torch.randn(*s, dtype=torch.bfloat16) * 0.8)(B, H, Sk, D)),
        "v": _w((lambda *s: torch.randn(*s, dtype=torch.bfloat16) * 0.05)(B, H, Sk, D)),
    }

def reference(q, k, v):
    scale = q.shape[-1] ** -0.5
    scores = torch.einsum("bhqd,bhkd->bhqk", q, k) * scale
    p = _softmax(scores, axis=-1)
    return torch.einsum("bhqk,bhkd->bhqd", p, v)
```

```asm
; @launch grid=(256,1,1) block=(512,1,1) lds=152064
.amdgcn_target "amdgcn-amd-amdhsa--gfx950"
.text
.globl standalone__mha_softmax__near_ridge_kernel
.p2align 8
.type standalone__mha_softmax__near_ridge_kernel,@function
standalone__mha_softmax__near_ridge_kernel:
    s_cmp_ge_u32 s2, 256
    s_cbranch_scc1 L_end
    s_load_dwordx8 s[4:11], s[0:1], 0
    v_lshrrev_b32 v14, 6, v0
    v_and_b32 v15, 63, v0
    v_readfirstlane_b32 s28, v14
    v_lshlrev_b32 v13, 6, v0
    v_lshlrev_b32 v1, 4, v15
    v_and_b32 v0, 0xf0, v1
    v_bfe_u32 v14, v15, 4, 1
    v_lshl_add_u32 v0, v14, 12, v0
    v_lshrrev_b32 v14, 5, v15
    v_lshl_add_u32 v0, v14, 8, v0
    s_and_b32 s3, s2, 7
    s_lshl_b32 s3, s3, 5
    s_lshr_b32 s34, s2, 3
    s_add_u32 s3, s3, s34
    s_lshl_b32 s3, s3, 16
    s_lshl_b32 s34, s28, 13
    s_add_u32 s38, s3, s34
    s_add_u32 s39, s38, 16777216
    s_lshl_b32 s34, s28, 10
    s_add_u32 s35, s3, s34
    s_add_u32 s36, s35, 16777216
    s_mul_i32 s32, s28, 1056
    s_add_u32 s32, s32, 67584
    s_mul_i32 s37, s28, 8448
    s_mov_b32 s29, 0
    s_mov_b32 s14, 0x2000000
    s_mov_b32 s15, 0x20000
    s_mov_b32 s18, 0x2000000
    s_mov_b32 s19, 0x20000
    s_mov_b32 s22, 0x2000000
    s_mov_b32 s23, 0x20000
    s_mov_b32 s26, 0x2000000
    s_mov_b32 s27, 0x20000
    s_waitcnt lgkmcnt(0)
    s_mov_b32 s12, s4
    s_and_b32 s13, s5, 0xffff
    s_mov_b32 s16, s6
    s_and_b32 s17, s7, 0xffff
    s_add_u32 m0, s37, 0
    s_add_u32 s34, s38, 0
    buffer_load_dwordx4 v0, s[12:15], s34 offen nt lds
    s_add_u32 m0, s37, 1056
    s_add_u32 s34, s38, 1024
    buffer_load_dwordx4 v0, s[12:15], s34 offen nt lds
    s_add_u32 m0, s37, 2112
    s_add_u32 s34, s38, 2048
    buffer_load_dwordx4 v0, s[12:15], s34 offen nt lds
    s_add_u32 m0, s37, 3168
    s_add_u32 s34, s38, 3072
    buffer_load_dwordx4 v0, s[12:15], s34 offen nt lds
    s_mov_b32 s20, s8
    s_and_b32 s21, s9, 0xffff
    s_mov_b32 s24, s10
    s_and_b32 s25, s11, 0xffff
L_pf:
    s_getpc_b64 s[4:5]
    v_min_u32 v13, L_end-L_pf-8, v13
    global_load_dword v88, v13, s[4:5]
    v_lshrrev_b32 v14, 4, v15
    v_and_b32 v12, 15, v15
    v_mul_u32_u24 v2, 1056, v12
    v_lshl_add_u32 v2, v14, 4, v2
    v_lshrrev_b32 v12, 2, v15
    v_mul_u32_u24 v3, 1056, v12
    v_and_b32 v12, 3, v15
    v_lshl_add_u32 v3, v12, 3, v3
    v_mul_u32_u24 v4, 1056, v12
    v_bfe_u32 v12, v15, 2, 2
    v_lshl_add_u32 v4, v12, 8, v4
    v_lshl_add_u32 v4, v14, 4, v4
    v_add_u32 v4, s37, v4
    v_and_b32 v12, 7, v15
    v_mul_u32_u24 v5, 1040, v12
    v_bfe_u32 v12, v15, 3, 1
    v_lshl_add_u32 v5, v12, 8, v5
    v_lshl_add_u32 v5, v14, 3, v5
    v_add_u32 v5, s37, v5
    v_add_u32 v6, s37, v1
    v_mov_b32 v20, 0x3f803f80
    v_mov_b32 v21, 0x3f803f80
    v_mov_b32 v22, 0x3f803f80
    v_mov_b32 v23, 0x3f803f80
    s_mov_b32 s30, 0x3e0293ee
    s_mov_b32 s31, 0xbe0293ee
    s_mov_b32 s33, 0x427af233
    s_waitcnt vmcnt(3)
    s_add_u32 m0, s32, 0
    s_add_u32 s34, s35, 0
    buffer_load_dwordx4 v1, s[16:19], s34 offen nt lds
    s_waitcnt vmcnt(3)
    s_add_u32 m0, s32, 8448
    s_add_u32 s34, s35, 8192
    buffer_load_dwordx4 v1, s[16:19], s34 offen nt lds
    s_waitcnt vmcnt(2)
    s_add_u32 m0, s32, 16896
    s_add_u32 s34, s35, 16384
    buffer_load_dwordx4 v1, s[16:19], s34 offen nt lds
    s_waitcnt vmcnt(2)
    s_add_u32 m0, s32, 25344
    s_add_u32 s34, s35, 24576
    buffer_load_dwordx4 v1, s[16:19], s34 offen nt lds
    ds_read_b128 v[56:59], v4 offset:0
    ds_read_b128 v[60:63], v4 offset:64
    ds_read_b128 v[64:67], v4 offset:128
    ds_read_b128 v[68:71], v4 offset:192
    s_waitcnt vmcnt(2)
    v_add_u32 v7, 67584, v2
    s_barrier
    ds_read_b128 v[24:27], v7 offset:0
    ds_read_b128 v[28:31], v7 offset:64
    ds_read_b128 v[32:35], v7 offset:128
    ds_read_b128 v[36:39], v7 offset:192
    ds_read_b128 v[40:43], v7 offset:256
    ds_read_b128 v[44:47], v7 offset:320
    ds_read_b128 v[48:51], v7 offset:384
    ds_read_b128 v[52:55], v7 offset:448
    s_waitcnt lgkmcnt(8)
    s_waitcnt lgkmcnt(7)
    v_mfma_f32_16x16x32_bf16 v[184:187], v[24:27], v[56:59], 0
    s_waitcnt lgkmcnt(6)
    ds_read_b128 v[24:27], v7 offset:512
    v_mfma_f32_16x16x32_bf16 v[184:187], v[28:31], v[60:63], v[184:187]
    s_waitcnt lgkmcnt(6)
    ds_read_b128 v[28:31], v7 offset:576
    s_add_u32 m0, s37, 4224
    s_add_u32 s34, s38, 512
    buffer_load_dwordx4 v0, s[12:15], s34 offen nt lds
    v_mfma_f32_16x16x32_bf16 v[184:187], v[32:35], v[64:67], v[184:187]
    s_waitcnt lgkmcnt(6)
    ds_read_b128 v[32:35], v7 offset:640
    v_mfma_f32_16x16x32_bf16 v[184:187], v[36:39], v[68:71], v[184:187]
    s_waitcnt lgkmcnt(6)
    ds_read_b128 v[36:39], v7 offset:704
    v_mfma_f32_16x16x32_bf16 v[188:191], v[40:43], v[56:59], 0
    s_waitcnt lgkmcnt(6)
    ds_read_b128 v[40:43], v7 offset:768
    v_mfma_f32_16x16x32_bf16 v[188:191], v[44:47], v[60:63], v[188:191]
    s_waitcnt lgkmcnt(6)
    ds_read_b128 v[44:47], v7 offset:832
    s_waitcnt vmcnt(2)
    s_add_u32 m0, s37, 5280
    s_add_u32 s34, s38, 1536
    buffer_load_dwordx4 v0, s[12:15], s34 offen nt lds
    v_mfma_f32_16x16x32_bf16 v[188:191], v[48:51], v[64:67], v[188:191]
    s_waitcnt lgkmcnt(6)
    ds_read_b128 v[48:51], v7 offset:896
    v_mfma_f32_16x16x32_bf16 v[188:191], v[52:55], v[68:71], v[188:191]
    s_waitcnt lgkmcnt(6)
    ds_read_b128 v[52:55], v7 offset:960
    v_mfma_f32_16x16x32_bf16 v[192:195], v[24:27], v[56:59], 0
    s_waitcnt lgkmcnt(6)
    s_waitcnt vmcnt(2)
    v_add_u32 v7, 84480, v2
    s_barrier
    ds_read_b128 v[24:27], v7 offset:0
    v_max_f32 v14, v184, v185
    v_max3_f32 v14, v186, v187, v14
    v_mfma_f32_16x16x32_bf16 v[192:195], v[28:31], v[60:63], v[192:195]
    s_waitcnt lgkmcnt(6)
    ds_read_b128 v[28:31], v7 offset:64
    v_mfma_f32_16x16x32_bf16 v[192:195], v[32:35], v[64:67], v[192:195]
    s_waitcnt lgkmcnt(6)
    ds_read_b128 v[32:35], v7 offset:128
    s_add_u32 m0, s37, 6336
    s_add_u32 s34, s38, 2560
    buffer_load_dwordx4 v0, s[12:15], s34 offen nt lds
    v_mfma_f32_16x16x32_bf16 v[192:195], v[36:39], v[68:71], v[192:195]
    s_waitcnt lgkmcnt(6)
    ds_read_b128 v[36:39], v7 offset:192
    v_mfma_f32_16x16x32_bf16 v[196:199], v[40:43], v[56:59], 0
    s_waitcnt lgkmcnt(6)
    ds_read_b128 v[40:43], v7 offset:256
    v_max3_f32 v14, v188, v189, v14
    v_max3_f32 v14, v190, v191, v14
    v_mfma_f32_16x16x32_bf16 v[196:199], v[44:47], v[60:63], v[196:199]
    s_waitcnt lgkmcnt(6)
    ds_read_b128 v[44:47], v7 offset:320
    v_mfma_f32_16x16x32_bf16 v[196:199], v[48:51], v[64:67], v[196:199]
    s_waitcnt lgkmcnt(6)
    ds_read_b128 v[48:51], v7 offset:384
    s_waitcnt vmcnt(2)
    s_add_u32 m0, s37, 7392
    s_add_u32 s34, s38, 3584
    buffer_load_dwordx4 v0, s[12:15], s34 offen nt lds
    v_mfma_f32_16x16x32_bf16 v[196:199], v[52:55], v[68:71], v[196:199]
    ds_read_b128 v[52:55], v7 offset:448
    s_waitcnt lgkmcnt(7)
    v_mfma_f32_16x16x32_bf16 v[216:219], v[24:27], v[56:59], 0
    s_waitcnt lgkmcnt(6)
    ds_read_b128 v[24:27], v7 offset:512
    v_max3_f32 v14, v192, v193, v14
    v_max3_f32 v14, v194, v195, v14
    s_nop 0
    v_max3_f32 v14, v196, v197, v14
    v_max3_f32 v14, v198, v199, v14
    v_mov_b32 v12, v14
    v_mfma_f32_16x16x32_bf16 v[216:219], v[28:31], v[60:63], v[216:219]
    s_waitcnt lgkmcnt(6)
    ds_read_b128 v[28:31], v7 offset:576
    v_permlane32_swap_b32 v14, v12
    v_max_f32 v14, v14, v12
    v_mov_b32 v12, v14
    s_nop 1
    v_permlane16_swap_b32 v14, v12
    v_max_f32 v14, v14, v12
    v_mfma_f32_16x16x32_bf16 v[216:219], v[32:35], v[64:67], v[216:219]
    s_waitcnt lgkmcnt(6)
    ds_read_b128 v[32:35], v7 offset:640
    v_mul_f32 v8, s31, v14
    v_add_f32 v10, s33, v14
    v_fma_f32 v184, v184, s30, v8
    v_fma_f32 v185, v185, s30, v8
    v_exp_f32 v184, v184
    v_mfma_f32_16x16x32_bf16 v[216:219], v[36:39], v[68:71], v[216:219]
    s_waitcnt lgkmcnt(6)
    ds_read_b128 v[36:39], v7 offset:704
    v_exp_f32 v185, v185
    v_fma_f32 v186, v186, s30, v8
    v_fma_f32 v187, v187, s30, v8
    v_exp_f32 v186, v186
    v_mfma_f32_16x16x32_bf16 v[220:223], v[40:43], v[56:59], 0
    s_waitcnt lgkmcnt(6)
    ds_read_b128 v[40:43], v7 offset:768
    v_cvt_pk_bf16_f32 v184, v184, v185
    v_exp_f32 v187, v187
    v_fma_f32 v188, v188, s30, v8
    v_mfma_f32_16x16x32_bf16 v[220:223], v[44:47], v[60:63], v[220:223]
    s_waitcnt lgkmcnt(6)
    ds_read_b128 v[44:47], v7 offset:832
    v_fma_f32 v189, v189, s30, v8
    v_exp_f32 v188, v188
    v_cvt_pk_bf16_f32 v185, v186, v187
    v_exp_f32 v189, v189
    v_mfma_f32_16x16x32_bf16 v[220:223], v[48:51], v[64:67], v[220:223]
    s_waitcnt lgkmcnt(6)
    ds_read_b128 v[48:51], v7 offset:896
    v_fma_f32 v190, v190, s30, v8
    v_fma_f32 v191, v191, s30, v8
    v_exp_f32 v190, v190
    v_mfma_f32_16x16x32_bf16 v[220:223], v[52:55], v[68:71], v[220:223]
    s_waitcnt lgkmcnt(6)
    ds_read_b128 v[52:55], v7 offset:960
    v_cvt_pk_bf16_f32 v186, v188, v189
    v_exp_f32 v191, v191
    v_fma_f32 v192, v192, s30, v8
    v_fma_f32 v193, v193, s30, v8
    v_mfma_f32_16x16x32_bf16 v[224:227], v[24:27], v[56:59], 0
    s_waitcnt lgkmcnt(6)
    v_add_u32 v7, 67584, v2
    ds_read_b128 v[24:27], v7 offset:0
    v_max_f32 v14, v216, v217
    v_max3_f32 v14, v218, v219, v14
    v_exp_f32 v192, v192
    v_cvt_pk_bf16_f32 v187, v190, v191
    v_mfma_f32_16x16x32_bf16 v[224:227], v[28:31], v[60:63], v[224:227]
    s_waitcnt lgkmcnt(6)
    ds_read_b128 v[28:31], v7 offset:64
    v_exp_f32 v193, v193
    v_fma_f32 v194, v194, s30, v8
    v_fma_f32 v195, v195, s30, v8
    v_exp_f32 v194, v194
    v_mfma_f32_16x16x32_bf16 v[224:227], v[32:35], v[64:67], v[224:227]
    s_waitcnt lgkmcnt(6)
    ds_read_b128 v[32:35], v7 offset:128
    s_waitcnt vmcnt(1)
    s_add_u32 m0, s32, 33792
    s_add_u32 s34, s35, 0
    buffer_load_dwordx4 v1, s[20:23], s34 offen nt lds
    v_cvt_pk_bf16_f32 v192, v192, v193
    v_exp_f32 v195, v195
    v_mfma_f32_16x16x32_bf16 v[224:227], v[36:39], v[68:71], v[224:227]
    s_waitcnt lgkmcnt(6)
    ds_read_b128 v[36:39], v7 offset:192
    v_fma_f32 v196, v196, s30, v8
    v_fma_f32 v197, v197, s30, v8
    v_exp_f32 v196, v196
    v_cvt_pk_bf16_f32 v193, v194, v195
    v_mfma_f32_16x16x32_bf16 v[228:231], v[40:43], v[56:59], 0
    s_waitcnt lgkmcnt(6)
    ds_read_b128 v[40:43], v7 offset:256
    v_max3_f32 v14, v220, v221, v14
    v_max3_f32 v14, v222, v223, v14
    v_exp_f32 v197, v197
    v_fma_f32 v198, v198, s30, v8
    v_mfma_f32_16x16x32_bf16 v[228:231], v[44:47], v[60:63], v[228:231]
    s_waitcnt lgkmcnt(6)
    ds_read_b128 v[44:47], v7 offset:320
    v_fma_f32 v199, v199, s30, v8
    v_exp_f32 v198, v198
    v_cvt_pk_bf16_f32 v194, v196, v197
    v_exp_f32 v199, v199
    v_mfma_f32_16x16x32_bf16 v[228:231], v[48:51], v[64:67], v[228:231]
    s_waitcnt lgkmcnt(6)
    ds_read_b128 v[48:51], v7 offset:384
    s_waitcnt vmcnt(1)
    s_add_u32 m0, s32, 42240
    s_add_u32 s34, s35, 8192
    buffer_load_dwordx4 v1, s[20:23], s34 offen nt lds
    v_cvt_pk_bf16_f32 v195, v198, v199
    v_mfma_f32_16x16x32_bf16 v[228:231], v[52:55], v[68:71], v[228:231]
    ds_read_b128 v[52:55], v7 offset:448
    ds_read_b128 v[72:75], v4 offset:4224
    ds_read_b128 v[76:79], v4 offset:4288
    ds_read_b128 v[80:83], v4 offset:4352
    ds_read_b128 v[84:87], v4 offset:4416
    s_waitcnt lgkmcnt(0)
    v_mfma_f32_16x16x32_bf16 v[200:203], v[24:27], v[72:75], 0
    ds_read_b128 v[24:27], v7 offset:512
    v_max3_f32 v14, v224, v225, v14
    v_mfma_f32_16x16x32_bf16 v[200:203], v[28:31], v[76:79], v[200:203]
    ds_read_b128 v[28:31], v7 offset:576
    v_max3_f32 v14, v226, v227, v14
    v_mfma_f32_16x16x32_bf16 v[200:203], v[32:35], v[80:83], v[200:203]
    ds_read_b128 v[32:35], v7 offset:640
    v_max3_f32 v14, v228, v229, v14
    v_mfma_f32_16x16x32_bf16 v[200:203], v[36:39], v[84:87], v[200:203]
    ds_read_b128 v[36:39], v7 offset:704
    v_max3_f32 v14, v230, v231, v14
    v_mfma_f32_16x16x32_bf16 v[204:207], v[40:43], v[72:75], 0
    ds_read_b128 v[40:43], v7 offset:768
    s_waitcnt vmcnt(1)
    s_add_u32 m0, s37, 0
    s_add_u32 s34, s39, 0
    buffer_load_dwordx4 v0, s[12:15], s34 offen nt lds
    v_mfma_f32_16x16x32_bf16 v[204:207], v[44:47], v[76:79], v[204:207]
    ds_read_b128 v[44:47], v7 offset:832
    v_mfma_f32_16x16x32_bf16 v[204:207], v[48:51], v[80:83], v[204:207]
    ds_read_b128 v[48:51], v7 offset:896
    v_mfma_f32_16x16x32_bf16 v[204:207], v[52:55], v[84:87], v[204:207]
    s_waitcnt lgkmcnt(6)
    ds_read_b128 v[52:55], v7 offset:960
    v_mfma_f32_16x16x32_bf16 v[208:211], v[24:27], v[72:75], 0
    s_waitcnt lgkmcnt(6)
    v_add_u32 v7, 84480, v2
    ds_read_b128 v[24:27], v7 offset:0
    v_max_f32 v15, v200, v201
    v_max3_f32 v15, v202, v203, v15
    v_mfma_f32_16x16x32_bf16 v[208:211], v[28:31], v[76:79], v[208:211]
    s_waitcnt lgkmcnt(6)
    ds_read_b128 v[28:31], v7 offset:64
    v_mfma_f32_16x16x32_bf16 v[208:211], v[32:35], v[80:83], v[208:211]
    s_waitcnt lgkmcnt(6)
    ds_read_b128 v[32:35], v7 offset:128
    v_mfma_f32_16x16x32_bf16 v[208:211], v[36:39], v[84:87], v[208:211]
    s_waitcnt lgkmcnt(6)
    ds_read_b128 v[36:39], v7 offset:192
    v_mfma_f32_16x16x32_bf16 v[212:215], v[40:43], v[72:75], 0
    s_waitcnt lgkmcnt(6)
    ds_read_b128 v[40:43], v7 offset:256
    s_waitcnt vmcnt(1)
    s_add_u32 m0, s37, 1056
    s_add_u32 s34, s39, 1024
    buffer_load_dwordx4 v0, s[12:15], s34 offen nt lds
    v_max3_f32 v15, v204, v205, v15
    v_max3_f32 v15, v206, v207, v15
    v_mfma_f32_16x16x32_bf16 v[212:215], v[44:47], v[76:79], v[212:215]
    s_waitcnt lgkmcnt(6)
    ds_read_b128 v[44:47], v7 offset:320
    v_mfma_f32_16x16x32_bf16 v[212:215], v[48:51], v[80:83], v[212:215]
    s_waitcnt lgkmcnt(6)
    ds_read_b128 v[48:51], v7 offset:384
    v_mfma_f32_16x16x32_bf16 v[212:215], v[52:55], v[84:87], v[212:215]
    ds_read_b128 v[52:55], v7 offset:448
    s_waitcnt lgkmcnt(7)
    v_mfma_f32_16x16x32_bf16 v[232:235], v[24:27], v[72:75], 0
    s_waitcnt lgkmcnt(6)
    ds_read_b128 v[24:27], v7 offset:512
    v_max3_f32 v15, v208, v209, v15
    v_max3_f32 v15, v210, v211, v15
    s_nop 0
    v_max3_f32 v15, v212, v213, v15
    v_max3_f32 v15, v214, v215, v15
    v_mov_b32 v13, v15
    s_nop 1
    v_permlane32_swap_b32 v15, v13
    v_mfma_f32_16x16x32_bf16 v[232:235], v[28:31], v[76:79], v[232:235]
    s_waitcnt lgkmcnt(6)
    ds_read_b128 v[28:31], v7 offset:576
    v_max_f32 v15, v15, v13
    v_mov_b32 v13, v15
    s_nop 1
    v_permlane16_swap_b32 v15, v13
    v_max_f32 v15, v15, v13
    v_mul_f32 v9, s31, v15
    v_add_f32 v11, s33, v15
    v_mfma_f32_16x16x32_bf16 v[232:235], v[32:35], v[80:83], v[232:235]
    s_waitcnt lgkmcnt(6)
    ds_read_b128 v[32:35], v7 offset:640
    v_fma_f32 v200, v200, s30, v9
    v_fma_f32 v201, v201, s30, v9
    v_exp_f32 v200, v200
    v_exp_f32 v201, v201
    v_mfma_f32_16x16x32_bf16 v[232:235], v[36:39], v[84:87], v[232:235]
    s_waitcnt lgkmcnt(6)
    ds_read_b128 v[36:39], v7 offset:704
    v_fma_f32 v202, v202, s30, v9
    v_fma_f32 v203, v203, s30, v9
    v_exp_f32 v202, v202
    v_cvt_pk_bf16_f32 v200, v200, v201
    v_mfma_f32_16x16x32_bf16 v[236:239], v[40:43], v[72:75], 0
    s_waitcnt lgkmcnt(6)
    ds_read_b128 v[40:43], v7 offset:768
    s_waitcnt vmcnt(1)
    s_add_u32 m0, s32, 50688
    s_add_u32 s34, s35, 32768
    buffer_load_dwordx4 v1, s[16:19], s34 offen nt lds
    v_exp_f32 v203, v203
    v_fma_f32 v204, v204, s30, v9
    v_mfma_f32_16x16x32_bf16 v[236:239], v[44:47], v[76:79], v[236:239]
    s_waitcnt lgkmcnt(6)
    ds_read_b128 v[44:47], v7 offset:832
    v_fma_f32 v205, v205, s30, v9
    v_exp_f32 v204, v204
    v_cvt_pk_bf16_f32 v201, v202, v203
    v_exp_f32 v205, v205
    v_mfma_f32_16x16x32_bf16 v[236:239], v[48:51], v[80:83], v[236:239]
    s_waitcnt lgkmcnt(6)
    ds_read_b128 v[48:51], v7 offset:896
    v_fma_f32 v206, v206, s30, v9
    v_fma_f32 v207, v207, s30, v9
    v_exp_f32 v206, v206
    v_cvt_pk_bf16_f32 v202, v204, v205
    v_exp_f32 v207, v207
    v_mfma_f32_16x16x32_bf16 v[236:239], v[52:55], v[84:87], v[236:239]
    s_waitcnt lgkmcnt(6)
    ds_read_b128 v[52:55], v7 offset:960
    v_fma_f32 v208, v208, s30, v9
    v_fma_f32 v209, v209, s30, v9
    v_exp_f32 v208, v208
    v_mfma_f32_16x16x32_bf16 v[240:243], v[24:27], v[72:75], 0
    s_waitcnt lgkmcnt(6)
    v_add_u32 v7, 101376, v3
    s_barrier
    ds_read_b64_tr_b16 v[24:25], v7 offset:0
    v_max_f32 v15, v232, v233
    v_max3_f32 v15, v234, v235, v15
    v_cvt_pk_bf16_f32 v203, v206, v207
    v_exp_f32 v209, v209
    v_fma_f32 v210, v210, s30, v9
    v_mfma_f32_16x16x32_bf16 v[240:243], v[28:31], v[76:79], v[240:243]
    s_waitcnt lgkmcnt(6)
    ds_read_b64_tr_b16 v[26:27], v7 offset:256
    v_fma_f32 v211, v211, s30, v9
    v_exp_f32 v210, v210
    v_cvt_pk_bf16_f32 v208, v208, v209
    v_exp_f32 v211, v211
    v_mfma_f32_16x16x32_bf16 v[240:243], v[32:35], v[80:83], v[240:243]
    s_waitcnt lgkmcnt(6)
    ds_read_b64_tr_b16 v[28:29], v7 offset:512
    v_fma_f32 v212, v212, s30, v9
    v_fma_f32 v213, v213, s30, v9
    v_exp_f32 v212, v212
    v_cvt_pk_bf16_f32 v209, v210, v211
    v_exp_f32 v213, v213
    v_mfma_f32_16x16x32_bf16 v[240:243], v[36:39], v[84:87], v[240:243]
    s_waitcnt lgkmcnt(6)
    ds_read_b64_tr_b16 v[30:31], v7 offset:768
    v_fma_f32 v214, v214, s30, v9
    v_fma_f32 v215, v215, s30, v9
    v_exp_f32 v214, v214
    v_mfma_f32_16x16x32_bf16 v[244:247], v[40:43], v[72:75], 0
    s_waitcnt lgkmcnt(6)
    ds_read_b64_tr_b16 v[32:33], v7 offset:32
    s_waitcnt vmcnt(1)
    s_add_u32 m0, s32, 59136
    s_add_u32 s34, s35, 40960
    buffer_load_dwordx4 v1, s[16:19], s34 offen nt lds
    v_max3_f32 v15, v236, v237, v15
    v_max3_f32 v15, v238, v239, v15
    v_cvt_pk_bf16_f32 v210, v212, v213
    v_exp_f32 v215, v215
    v_mfma_f32_16x16x32_bf16 v[244:247], v[44:47], v[76:79], v[244:247]
    s_waitcnt lgkmcnt(6)
    ds_read_b64_tr_b16 v[34:35], v7 offset:288
    v_cvt_pk_bf16_f32 v211, v214, v215
    v_mfma_f32_16x16x32_bf16 v[244:247], v[48:51], v[80:83], v[244:247]
    s_waitcnt lgkmcnt(6)
    ds_read_b64_tr_b16 v[36:37], v7 offset:544
    s_waitcnt vmcnt(1)
    s_add_u32 m0, s37, 2112
    s_add_u32 s34, s39, 2048
    buffer_load_dwordx4 v0, s[12:15], s34 offen nt lds
    v_mfma_f32_16x16x32_bf16 v[244:247], v[52:55], v[84:87], v[244:247]
    ds_read_b64_tr_b16 v[38:39], v7 offset:800
    v_mfma_f32_16x16x32_bf16 v[248:251], v[20:23], v[184:187], 0
    ds_read_b64_tr_b16 v[40:41], v7 offset:64
    v_max3_f32 v15, v240, v241, v15
    v_max3_f32 v15, v242, v243, v15
    v_mfma_f32_16x16x32_bf16 v[248:251], v[20:23], v[192:195], v[248:251]
    ds_read_b64_tr_b16 v[42:43], v7 offset:320
    s_nop 0
    v_max3_f32 v15, v244, v245, v15
    v_max3_f32 v15, v246, v247, v15
    v_mfma_f32_16x16x32_bf16 v[252:255], v[20:23], v[200:203], 0
    ds_read_b64_tr_b16 v[44:45], v7 offset:576
    s_waitcnt vmcnt(1)
    s_add_u32 m0, s37, 3168
    s_add_u32 s34, s39, 3072
    buffer_load_dwordx4 v0, s[12:15], s34 offen nt lds
    v_mfma_f32_16x16x32_bf16 v[252:255], v[20:23], v[208:211], v[252:255]
    s_waitcnt lgkmcnt(7)
    ds_read_b64_tr_b16 v[46:47], v7 offset:832
    v_cmp_gt_f32 vcc, v14, v10
    v_cmp_gt_f32 s[42:43], v15, v11
    s_nop 3
    s_or_b64 s[42:43], s[42:43], vcc
    s_cbranch_scc0 L_nr1
    s_call_b64 s[40:41], L_newmax
L_nr1:
    v_fma_f32 v216, v216, s30, v8
    v_mfma_f32_16x16x32_bf16 v[120:123], v[24:27], v[184:187], 0
    ds_read_b64_tr_b16 v[48:49], v7 offset:96
    v_fma_f32 v217, v217, s30, v8
    v_exp_f32 v216, v216
    v_mfma_f32_16x16x32_bf16 v[120:123], v[28:31], v[192:195], v[120:123]
    ds_read_b64_tr_b16 v[50:51], v7 offset:352
    v_exp_f32 v217, v217
    v_mfma_f32_16x16x32_bf16 v[152:155], v[24:27], v[200:203], 0
    ds_read_b64_tr_b16 v[52:53], v7 offset:608
    v_fma_f32 v232, v232, s30, v9
    v_fma_f32 v233, v233, s30, v9
    v_mfma_f32_16x16x32_bf16 v[152:155], v[28:31], v[208:211], v[152:155]
    s_waitcnt lgkmcnt(7)
    ds_read_b64_tr_b16 v[54:55], v7 offset:864
    v_exp_f32 v232, v232
    v_mfma_f32_16x16x32_bf16 v[124:127], v[32:35], v[184:187], 0
    ds_read_b64_tr_b16 v[24:25], v7 offset:128
    v_cvt_pk_bf16_f32 v216, v216, v217
    v_exp_f32 v233, v233
    v_mfma_f32_16x16x32_bf16 v[124:127], v[36:39], v[192:195], v[124:127]
    ds_read_b64_tr_b16 v[26:27], v7 offset:384
    v_fma_f32 v218, v218, s30, v8
    v_mfma_f32_16x16x32_bf16 v[156:159], v[32:35], v[200:203], 0
    ds_read_b64_tr_b16 v[28:29], v7 offset:640
    v_fma_f32 v219, v219, s30, v8
    v_exp_f32 v218, v218
    v_mfma_f32_16x16x32_bf16 v[156:159], v[36:39], v[208:211], v[156:159]
    s_waitcnt lgkmcnt(7)
    ds_read_b64_tr_b16 v[30:31], v7 offset:896
    v_cvt_pk_bf16_f32 v232, v232, v233
    v_mfma_f32_16x16x32_bf16 v[128:131], v[40:43], v[184:187], 0
    ds_read_b64_tr_b16 v[32:33], v7 offset:160
    s_waitcnt vmcnt(1)
    s_add_u32 m0, s32, 67584
    s_add_u32 s34, s35, 16384
    buffer_load_dwordx4 v1, s[20:23], s34 offen nt lds
    v_mfma_f32_16x16x32_bf16 v[128:131], v[44:47], v[192:195], v[128:131]
    ds_read_b64_tr_b16 v[34:35], v7 offset:416
    v_exp_f32 v219, v219
    v_mfma_f32_16x16x32_bf16 v[160:163], v[40:43], v[200:203], 0
    ds_read_b64_tr_b16 v[36:37], v7 offset:672
    v_fma_f32 v234, v234, s30, v9
    v_fma_f32 v235, v235, s30, v9
    v_mfma_f32_16x16x32_bf16 v[160:163], v[44:47], v[208:211], v[160:163]
    s_waitcnt lgkmcnt(7)
    ds_read_b64_tr_b16 v[38:39], v7 offset:928
    v_exp_f32 v234, v234
    v_mfma_f32_16x16x32_bf16 v[132:135], v[48:51], v[184:187], 0
    ds_read_b64_tr_b16 v[40:41], v7 offset:192
    v_cvt_pk_bf16_f32 v217, v218, v219
    v_exp_f32 v235, v235
    v_mfma_f32_16x16x32_bf16 v[132:135], v[52:55], v[192:195], v[132:135]
    ds_read_b64_tr_b16 v[42:43], v7 offset:448
    v_fma_f32 v220, v220, s30, v8
    v_fma_f32 v221, v221, s30, v8
    v_mfma_f32_16x16x32_bf16 v[164:167], v[48:51], v[200:203], 0
    ds_read_b64_tr_b16 v[44:45], v7 offset:704
    v_exp_f32 v220, v220
    v_mfma_f32_16x16x32_bf16 v[164:167], v[52:55], v[208:211], v[164:167]
    s_waitcnt lgkmcnt(7)
    ds_read_b64_tr_b16 v[46:47], v7 offset:960
    v_cvt_pk_bf16_f32 v233, v234, v235
    v_exp_f32 v221, v221
    v_mfma_f32_16x16x32_bf16 v[136:139], v[24:27], v[184:187], 0
    ds_read_b64_tr_b16 v[48:49], v7 offset:224
    v_fma_f32 v236, v236, s30, v9
    v_mfma_f32_16x16x32_bf16 v[136:139], v[28:31], v[192:195], v[136:139]
    ds_read_b64_tr_b16 v[50:51], v7 offset:480
    v_fma_f32 v237, v237, s30, v9
    v_exp_f32 v236, v236
    v_mfma_f32_16x16x32_bf16 v[168:171], v[24:27], v[200:203], 0
    ds_read_b64_tr_b16 v[52:53], v7 offset:736
    v_cvt_pk_bf16_f32 v218, v220, v221
    v_mfma_f32_16x16x32_bf16 v[168:171], v[28:31], v[208:211], v[168:171]
    s_waitcnt lgkmcnt(7)
    ds_read_b64_tr_b16 v[54:55], v7 offset:992
    v_exp_f32 v237, v237
    v_mfma_f32_16x16x32_bf16 v[140:143], v[32:35], v[184:187], 0
    v_add_u32 v7, 118272, v2
    s_barrier
    ds_read_b128 v[24:27], v7 offset:0
    v_fma_f32 v222, v222, s30, v8
    v_fma_f32 v223, v223, s30, v8
    v_mfma_f32_16x16x32_bf16 v[140:143], v[36:39], v[192:195], v[140:143]
    ds_read_b128 v[28:31], v7 offset:64
    s_waitcnt vmcnt(1)
    s_add_u32 m0, s32, 76032
    s_add_u32 s34, s35, 24576
    buffer_load_dwordx4 v1, s[20:23], s34 offen nt lds
    v_mfma_f32_16x16x32_bf16 v[172:175], v[32:35], v[200:203], 0
    ds_read_b128 v[32:35], v7 offset:128
    v_exp_f32 v222, v222
    v_mfma_f32_16x16x32_bf16 v[172:175], v[36:39], v[208:211], v[172:175]
    s_waitcnt lgkmcnt(7)
    ds_read_b128 v[36:39], v7 offset:192
    v_cvt_pk_bf16_f32 v234, v236, v237
    v_exp_f32 v223, v223
    v_mfma_f32_16x16x32_bf16 v[144:147], v[40:43], v[184:187], 0
    v_fma_f32 v238, v238, s30, v9
    v_fma_f32 v239, v239, s30, v9
    v_mfma_f32_16x16x32_bf16 v[144:147], v[44:47], v[192:195], v[144:147]
    v_exp_f32 v238, v238
    v_cvt_pk_bf16_f32 v219, v222, v223
    v_mfma_f32_16x16x32_bf16 v[176:179], v[40:43], v[200:203], 0
    ds_read_b128 v[40:43], v7 offset:256
    v_exp_f32 v239, v239
    v_mfma_f32_16x16x32_bf16 v[176:179], v[44:47], v[208:211], v[176:179]
    s_waitcnt lgkmcnt(5)
    ds_read_b128 v[44:47], v7 offset:320
    v_fma_f32 v224, v224, s30, v8
    v_fma_f32 v225, v225, s30, v8
    v_exp_f32 v224, v224
    v_mfma_f32_16x16x32_bf16 v[148:151], v[48:51], v[184:187], 0
    v_cvt_pk_bf16_f32 v235, v238, v239
    v_exp_f32 v225, v225
    v_mfma_f32_16x16x32_bf16 v[148:151], v[52:55], v[192:195], v[148:151]
    v_fma_f32 v240, v240, s30, v9
    v_fma_f32 v241, v241, s30, v9
    v_mfma_f32_16x16x32_bf16 v[180:183], v[48:51], v[200:203], 0
    ds_read_b128 v[48:51], v7 offset:384
    v_exp_f32 v240, v240
    v_mfma_f32_16x16x32_bf16 v[180:183], v[52:55], v[208:211], v[180:183]
    ds_read_b128 v[52:55], v7 offset:448
    v_cvt_pk_bf16_f32 v224, v224, v225
    v_exp_f32 v241, v241
    v_fma_f32 v226, v226, s30, v8
    v_fma_f32 v227, v227, s30, v8
    v_exp_f32 v226, v226
    v_cvt_pk_bf16_f32 v240, v240, v241
    v_exp_f32 v227, v227
    s_waitcnt lgkmcnt(7)
    v_mfma_f32_16x16x32_bf16 v[184:187], v[24:27], v[56:59], 0
    s_waitcnt lgkmcnt(6)
    v_fma_f32 v242, v242, s30, v9
    v_fma_f32 v243, v243, s30, v9
    v_exp_f32 v242, v242
    v_mfma_f32_16x16x32_bf16 v[184:187], v[28:31], v[60:63], v[184:187]
    s_waitcnt lgkmcnt(5)
    v_cvt_pk_bf16_f32 v225, v226, v227
    v_mfma_f32_16x16x32_bf16 v[184:187], v[32:35], v[64:67], v[184:187]
    s_waitcnt lgkmcnt(4)
    s_waitcnt vmcnt(1)
    s_add_u32 m0, s37, 4224
    s_add_u32 s34, s39, 512
    buffer_load_dwordx4 v0, s[12:15], s34 offen nt lds
    v_mfma_f32_16x16x32_bf16 v[184:187], v[36:39], v[68:71], v[184:187]
    v_exp_f32 v243, v243
    v_fma_f32 v228, v228, s30, v8
    v_mfma_f32_16x16x32_bf16 v[200:203], v[24:27], v[72:75], 0
    ds_read_b128 v[24:27], v7 offset:512
    v_fma_f32 v229, v229, s30, v8
    v_exp_f32 v228, v228
    v_mfma_f32_16x16x32_bf16 v[200:203], v[28:31], v[76:79], v[200:203]
    ds_read_b128 v[28:31], v7 offset:576
    v_mfma_f32_16x16x32_bf16 v[200:203], v[32:35], v[80:83], v[200:203]
    ds_read_b128 v[32:35], v7 offset:640
    v_cvt_pk_bf16_f32 v241, v242, v243
    v_exp_f32 v229, v229
    v_mfma_f32_16x16x32_bf16 v[200:203], v[36:39], v[84:87], v[200:203]
    s_waitcnt lgkmcnt(6)
    ds_read_b128 v[36:39], v7 offset:704
    v_mfma_f32_16x16x32_bf16 v[188:191], v[40:43], v[56:59], 0
    s_waitcnt lgkmcnt(6)
    v_max_f32 v14, v184, v185
    v_max3_f32 v14, v186, v187, v14
    v_fma_f32 v244, v244, s30, v9
    v_mfma_f32_16x16x32_bf16 v[188:191], v[44:47], v[60:63], v[188:191]
    s_waitcnt lgkmcnt(5)
    v_fma_f32 v245, v245, s30, v9
    v_exp_f32 v244, v244
    v_mfma_f32_16x16x32_bf16 v[188:191], v[48:51], v[64:67], v[188:191]
    s_waitcnt lgkmcnt(4)
    v_cvt_pk_bf16_f32 v226, v228, v229
    v_exp_f32 v245, v245
    v_mfma_f32_16x16x32_bf16 v[188:191], v[52:55], v[68:71], v[188:191]
    v_fma_f32 v230, v230, s30, v8
    v_fma_f32 v231, v231, s30, v8
    v_mfma_f32_16x16x32_bf16 v[204:207], v[40:43], v[72:75], 0
    ds_read_b128 v[40:43], v7 offset:768
    s_waitcnt vmcnt(1)
    s_add_u32 m0, s32, 0
    s_add_u32 s34, s35, 49152
    buffer_load_dwordx4 v1, s[16:19], s34 offen nt lds
    v_mfma_f32_16x16x32_bf16 v[204:207], v[44:47], v[76:79], v[204:207]
    ds_read_b128 v[44:47], v7 offset:832
    v_max_f32 v15, v200, v201
    v_mfma_f32_16x16x32_bf16 v[204:207], v[48:51], v[80:83], v[204:207]
    ds_read_b128 v[48:51], v7 offset:896
    v_max3_f32 v15, v202, v203, v15
    v_mfma_f32_16x16x32_bf16 v[204:207], v[52:55], v[84:87], v[204:207]
    s_waitcnt lgkmcnt(6)
    ds_read_b128 v[52:55], v7 offset:960
    v_exp_f32 v230, v230
    v_mfma_f32_16x16x32_bf16 v[192:195], v[24:27], v[56:59], 0
    s_waitcnt lgkmcnt(6)
    v_max3_f32 v14, v188, v189, v14
    v_max3_f32 v14, v190, v191, v14
    v_mfma_f32_16x16x32_bf16 v[192:195], v[28:31], v[60:63], v[192:195]
    s_waitcnt lgkmcnt(5)
    v_cvt_pk_bf16_f32 v242, v244, v245
    v_exp_f32 v231, v231
    v_mfma_f32_16x16x32_bf16 v[192:195], v[32:35], v[64:67], v[192:195]
    s_waitcnt lgkmcnt(4)
    v_fma_f32 v246, v246, s30, v9
    v_fma_f32 v247, v247, s30, v9
    v_exp_f32 v246, v246
    v_mfma_f32_16x16x32_bf16 v[192:195], v[36:39], v[68:71], v[192:195]
    v_cvt_pk_bf16_f32 v227, v230, v231
    v_mfma_f32_16x16x32_bf16 v[208:211], v[24:27], v[72:75], 0
    v_add_u32 v7, 135168, v3
    s_barrier
    ds_read_b64_tr_b16 v[24:25], v7 offset:0
    v_max3_f32 v15, v204, v205, v15
    v_max3_f32 v15, v206, v207, v15
    v_mfma_f32_16x16x32_bf16 v[208:211], v[28:31], v[76:79], v[208:211]
    ds_read_b64_tr_b16 v[26:27], v7 offset:256
    v_exp_f32 v247, v247
    v_mfma_f32_16x16x32_bf16 v[208:211], v[32:35], v[80:83], v[208:211]
    ds_read_b64_tr_b16 v[28:29], v7 offset:512
    v_cvt_pk_bf16_f32 v243, v246, v247
    v_mfma_f32_16x16x32_bf16 v[208:211], v[36:39], v[84:87], v[208:211]
    s_waitcnt lgkmcnt(6)
    ds_read_b64_tr_b16 v[30:31], v7 offset:768
    v_mfma_f32_16x16x32_bf16 v[196:199], v[40:43], v[56:59], 0
    s_waitcnt lgkmcnt(6)
    ds_read_b64_tr_b16 v[32:33], v7 offset:32
    v_max3_f32 v14, v192, v193, v14
    v_max3_f32 v14, v194, v195, v14
    v_mfma_f32_16x16x32_bf16 v[196:199], v[44:47], v[60:63], v[196:199]
    s_waitcnt lgkmcnt(6)
    ds_read_b64_tr_b16 v[34:35], v7 offset:288
    s_waitcnt vmcnt(1)
    s_add_u32 m0, s32, 8448
    s_add_u32 s34, s35, 57344
    buffer_load_dwordx4 v1, s[16:19], s34 offen nt lds
    v_mfma_f32_16x16x32_bf16 v[196:199], v[48:51], v[64:67], v[196:199]
    s_waitcnt lgkmcnt(6)
    ds_read_b64_tr_b16 v[36:37], v7 offset:544
    v_mfma_f32_16x16x32_bf16 v[196:199], v[52:55], v[68:71], v[196:199]
    ds_read_b64_tr_b16 v[38:39], v7 offset:800
    v_mfma_f32_16x16x32_bf16 v[212:215], v[40:43], v[72:75], 0
    ds_read_b64_tr_b16 v[40:41], v7 offset:64
    v_max3_f32 v15, v208, v209, v15
    v_max3_f32 v15, v210, v211, v15
    v_mfma_f32_16x16x32_bf16 v[212:215], v[44:47], v[76:79], v[212:215]
    ds_read_b64_tr_b16 v[42:43], v7 offset:320
    v_mfma_f32_16x16x32_bf16 v[212:215], v[48:51], v[80:83], v[212:215]
    ds_read_b64_tr_b16 v[44:45], v7 offset:576
    v_mfma_f32_16x16x32_bf16 v[212:215], v[52:55], v[84:87], v[212:215]
    ds_read_b64_tr_b16 v[46:47], v7 offset:832
    s_cmp_eq_u32 s29, 0
    s_cbranch_scc1 L_nr2
    s_call_b64 s[40:41], L_rescale
L_nr2:
    v_mfma_f32_16x16x32_bf16 v[248:251], v[20:23], v[216:219], v[248:251]
    ds_read_b64_tr_b16 v[48:49], v7 offset:96
    v_max3_f32 v14, v196, v197, v14
    v_max3_f32 v14, v198, v199, v14
    v_mfma_f32_16x16x32_bf16 v[248:251], v[20:23], v[224:227], v[248:251]
    ds_read_b64_tr_b16 v[50:51], v7 offset:352
    v_max3_f32 v15, v212, v213, v15
    v_max3_f32 v15, v214, v215, v15
    v_mfma_f32_16x16x32_bf16 v[252:255], v[20:23], v[232:235], v[252:255]
    ds_read_b64_tr_b16 v[52:53], v7 offset:608
    s_add_u32 m0, s37, 5280
    s_add_u32 s34, s39, 1536
    buffer_load_dwordx4 v0, s[12:15], s34 offen nt lds
    v_mfma_f32_16x16x32_bf16 v[252:255], v[20:23], v[240:243], v[252:255]
    s_waitcnt lgkmcnt(11)
    ds_read_b64_tr_b16 v[54:55], v7 offset:864
    v_cmp_gt_f32 vcc, v14, v10
    v_cmp_gt_f32 s[42:43], v15, v11
    s_nop 3
    s_or_b64 s[42:43], s[42:43], vcc
    s_cbranch_scc0 L_nr3
    s_call_b64 s[40:41], L_newmax
L_nr3:
    v_fma_f32 v184, v184, s30, v8
    v_mfma_f32_16x16x32_bf16 v[120:123], v[24:27], v[216:219], v[120:123]
    v_fma_f32 v185, v185, s30, v8
    v_exp_f32 v184, v184
    v_exp_f32 v185, v185
    v_mfma_f32_16x16x32_bf16 v[120:123], v[28:31], v[224:227], v[120:123]
    v_fma_f32 v200, v200, s30, v9
    v_fma_f32 v201, v201, s30, v9
    v_mfma_f32_16x16x32_bf16 v[152:155], v[24:27], v[232:235], v[152:155]
    ds_read_b64_tr_b16 v[24:25], v7 offset:128
    v_exp_f32 v200, v200
    v_mfma_f32_16x16x32_bf16 v[152:155], v[28:31], v[240:243], v[152:155]
    s_waitcnt lgkmcnt(9)
    ds_read_b64_tr_b16 v[26:27], v7 offset:384
    v_cvt_pk_bf16_f32 v184, v184, v185
    v_exp_f32 v201, v201
    v_mfma_f32_16x16x32_bf16 v[124:127], v[32:35], v[216:219], v[124:127]
    ds_read_b64_tr_b16 v[28:29], v7 offset:640
    v_fma_f32 v186, v186, s30, v8
    v_mfma_f32_16x16x32_bf16 v[124:127], v[36:39], v[224:227], v[124:127]
    ds_read_b64_tr_b16 v[30:31], v7 offset:896
    v_fma_f32 v187, v187, s30, v8
    v_exp_f32 v186, v186
    v_mfma_f32_16x16x32_bf16 v[156:159], v[32:35], v[232:235], v[156:159]
    ds_read_b64_tr_b16 v[32:33], v7 offset:160
    v_cvt_pk_bf16_f32 v200, v200, v201
    v_mfma_f32_16x16x32_bf16 v[156:159], v[36:39], v[240:243], v[156:159]
    s_waitcnt lgkmcnt(9)
    ds_read_b64_tr_b16 v[34:35], v7 offset:416
    v_exp_f32 v187, v187
    v_mfma_f32_16x16x32_bf16 v[128:131], v[40:43], v[216:219], v[128:131]
    ds_read_b64_tr_b16 v[36:37], v7 offset:672
    s_waitcnt vmcnt(2)
    s_add_u32 m0, s32, 16896
    s_add_u32 s34, s35, 32768
    buffer_load_dwordx4 v1, s[20:23], s34 offen nt lds
    v_mfma_f32_16x16x32_bf16 v[128:131], v[44:47], v[224:227], v[128:131]
    ds_read_b64_tr_b16 v[38:39], v7 offset:928
    v_fma_f32 v202, v202, s30, v9
    v_fma_f32 v203, v203, s30, v9
    v_mfma_f32_16x16x32_bf16 v[160:163], v[40:43], v[232:235], v[160:163]
    ds_read_b64_tr_b16 v[40:41], v7 offset:192
    v_exp_f32 v202, v202
    v_mfma_f32_16x16x32_bf16 v[160:163], v[44:47], v[240:243], v[160:163]
    s_waitcnt lgkmcnt(9)
    ds_read_b64_tr_b16 v[42:43], v7 offset:448
    v_cvt_pk_bf16_f32 v185, v186, v187
    v_exp_f32 v203, v203
    v_mfma_f32_16x16x32_bf16 v[132:135], v[48:51], v[216:219], v[132:135]
    ds_read_b64_tr_b16 v[44:45], v7 offset:704
    v_fma_f32 v188, v188, s30, v8
    v_mfma_f32_16x16x32_bf16 v[132:135], v[52:55], v[224:227], v[132:135]
    ds_read_b64_tr_b16 v[46:47], v7 offset:960
    v_fma_f32 v189, v189, s30, v8
    v_exp_f32 v188, v188
    v_mfma_f32_16x16x32_bf16 v[164:167], v[48:51], v[232:235], v[164:167]
    ds_read_b64_tr_b16 v[48:49], v7 offset:224
    v_cvt_pk_bf16_f32 v201, v202, v203
    v_exp_f32 v189, v189
    v_mfma_f32_16x16x32_bf16 v[164:167], v[52:55], v[240:243], v[164:167]
    s_waitcnt lgkmcnt(9)
    ds_read_b64_tr_b16 v[50:51], v7 offset:480
    v_fma_f32 v204, v204, s30, v9
    v_mfma_f32_16x16x32_bf16 v[136:139], v[24:27], v[216:219], v[136:139]
    ds_read_b64_tr_b16 v[52:53], v7 offset:736
    v_fma_f32 v205, v205, s30, v9
    v_exp_f32 v204, v204
    v_mfma_f32_16x16x32_bf16 v[136:139], v[28:31], v[224:227], v[136:139]
    ds_read_b64_tr_b16 v[54:55], v7 offset:992
    v_cvt_pk_bf16_f32 v186, v188, v189
    v_mfma_f32_16x16x32_bf16 v[168:171], v[24:27], v[232:235], v[168:171]
    s_waitcnt vmcnt(2)
    v_add_u32 v7, 67584, v2
    s_barrier
    ds_read_b128 v[24:27], v7 offset:0
    v_exp_f32 v205, v205
    v_mfma_f32_16x16x32_bf16 v[168:171], v[28:31], v[240:243], v[168:171]
    s_waitcnt lgkmcnt(9)
    ds_read_b128 v[28:31], v7 offset:64
    v_fma_f32 v190, v190, s30, v8
    v_fma_f32 v191, v191, s30, v8
    v_mfma_f32_16x16x32_bf16 v[140:143], v[32:35], v[216:219], v[140:143]
    v_exp_f32 v190, v190
    v_cvt_pk_bf16_f32 v202, v204, v205
    v_mfma_f32_16x16x32_bf16 v[140:143], v[36:39], v[224:227], v[140:143]
    s_add_u32 m0, s32, 25344
    s_add_u32 s34, s35, 40960
    buffer_load_dwordx4 v1, s[20:23], s34 offen nt lds
    v_exp_f32 v191, v191
    v_mfma_f32_16x16x32_bf16 v[172:175], v[32:35], v[232:235], v[172:175]
    ds_read_b128 v[32:35], v7 offset:128
    v_fma_f32 v206, v206, s30, v9
    v_mfma_f32_16x16x32_bf16 v[172:175], v[36:39], v[240:243], v[172:175]
    s_waitcnt lgkmcnt(7)
    ds_read_b128 v[36:39], v7 offset:192
    v_fma_f32 v207, v207, s30, v9
    v_exp_f32 v206, v206
    v_mfma_f32_16x16x32_bf16 v[144:147], v[40:43], v[216:219], v[144:147]
    v_cvt_pk_bf16_f32 v187, v190, v191
    v_exp_f32 v207, v207
    v_mfma_f32_16x16x32_bf16 v[144:147], v[44:47], v[224:227], v[144:147]
    v_fma_f32 v192, v192, s30, v8
    v_fma_f32 v193, v193, s30, v8
    v_mfma_f32_16x16x32_bf16 v[176:179], v[40:43], v[232:235], v[176:179]
    ds_read_b128 v[40:43], v7 offset:256
    v_exp_f32 v192, v192
    v_mfma_f32_16x16x32_bf16 v[176:179], v[44:47], v[240:243], v[176:179]
    s_waitcnt lgkmcnt(5)
    ds_read_b128 v[44:47], v7 offset:320
    v_cvt_pk_bf16_f32 v203, v206, v207
    v_exp_f32 v193, v193
    v_mfma_f32_16x16x32_bf16 v[148:151], v[48:51], v[216:219], v[148:151]
    v_fma_f32 v208, v208, s30, v9
    v_fma_f32 v209, v209, s30, v9
    v_exp_f32 v208, v208
    v_mfma_f32_16x16x32_bf16 v[148:151], v[52:55], v[224:227], v[148:151]
    v_cvt_pk_bf16_f32 v192, v192, v193
    v_exp_f32 v209, v209
    v_mfma_f32_16x16x32_bf16 v[180:183], v[48:51], v[232:235], v[180:183]
    ds_read_b128 v[48:51], v7 offset:384
    v_fma_f32 v194, v194, s30, v8
    v_mfma_f32_16x16x32_bf16 v[180:183], v[52:55], v[240:243], v[180:183]
    ds_read_b128 v[52:55], v7 offset:448
    v_fma_f32 v195, v195, s30, v8
    v_exp_f32 v194, v194
    v_cvt_pk_bf16_f32 v208, v208, v209
    v_exp_f32 v195, v195
    s_waitcnt lgkmcnt(7)
    v_mfma_f32_16x16x32_bf16 v[216:219], v[24:27], v[56:59], 0
    s_waitcnt lgkmcnt(6)
    v_fma_f32 v210, v210, s30, v9
    v_fma_f32 v211, v211, s30, v9
    v_exp_f32 v210, v210
    v_mfma_f32_16x16x32_bf16 v[216:219], v[28:31], v[60:63], v[216:219]
    s_waitcnt lgkmcnt(5)
    v_cvt_pk_bf16_f32 v193, v194, v195
    v_mfma_f32_16x16x32_bf16 v[216:219], v[32:35], v[64:67], v[216:219]
    s_waitcnt lgkmcnt(4)
    s_waitcnt vmcnt(2)
    s_add_u32 m0, s37, 6336
    s_add_u32 s34, s39, 2560
    buffer_load_dwordx4 v0, s[12:15], s34 offen nt lds
    v_mfma_f32_16x16x32_bf16 v[216:219], v[36:39], v[68:71], v[216:219]
    v_exp_f32 v211, v211
    v_fma_f32 v196, v196, s30, v8
    v_mfma_f32_16x16x32_bf16 v[232:235], v[24:27], v[72:75], 0
    ds_read_b128 v[24:27], v7 offset:512
    v_fma_f32 v197, v197, s30, v8
    v_exp_f32 v196, v196
    v_mfma_f32_16x16x32_bf16 v[232:235], v[28:31], v[76:79], v[232:235]
    ds_read_b128 v[28:31], v7 offset:576
    v_mfma_f32_16x16x32_bf16 v[232:235], v[32:35], v[80:83], v[232:235]
    ds_read_b128 v[32:35], v7 offset:640
    v_cvt_pk_bf16_f32 v209, v210, v211
    v_exp_f32 v197, v197
    v_mfma_f32_16x16x32_bf16 v[232:235], v[36:39], v[84:87], v[232:235]
    s_waitcnt lgkmcnt(6)
    ds_read_b128 v[36:39], v7 offset:704
    v_mfma_f32_16x16x32_bf16 v[220:223], v[40:43], v[56:59], 0
    s_waitcnt lgkmcnt(6)
    v_max_f32 v14, v216, v217
    v_max3_f32 v14, v218, v219, v14
    v_fma_f32 v212, v212, s30, v9
    v_mfma_f32_16x16x32_bf16 v[220:223], v[44:47], v[60:63], v[220:223]
    s_waitcnt lgkmcnt(5)
    v_fma_f32 v213, v213, s30, v9
    v_exp_f32 v212, v212
    v_mfma_f32_16x16x32_bf16 v[220:223], v[48:51], v[64:67], v[220:223]
    s_waitcnt lgkmcnt(4)
    v_cvt_pk_bf16_f32 v194, v196, v197
    v_exp_f32 v213, v213
    v_mfma_f32_16x16x32_bf16 v[220:223], v[52:55], v[68:71], v[220:223]
    v_fma_f32 v198, v198, s30, v8
    v_fma_f32 v199, v199, s30, v8
    v_mfma_f32_16x16x32_bf16 v[236:239], v[40:43], v[72:75], 0
    ds_read_b128 v[40:43], v7 offset:768
    s_waitcnt vmcnt(2)
    s_add_u32 m0, s32, 33792
    s_add_u32 s34, s36, 0
    buffer_load_dwordx4 v1, s[16:19], s34 offen nt lds
    v_mfma_f32_16x16x32_bf16 v[236:239], v[44:47], v[76:79], v[236:239]
    ds_read_b128 v[44:47], v7 offset:832
    v_max_f32 v15, v232, v233
    v_mfma_f32_16x16x32_bf16 v[236:239], v[48:51], v[80:83], v[236:239]
    ds_read_b128 v[48:51], v7 offset:896
    v_max3_f32 v15, v234, v235, v15
    v_mfma_f32_16x16x32_bf16 v[236:239], v[52:55], v[84:87], v[236:239]
    s_waitcnt lgkmcnt(6)
    ds_read_b128 v[52:55], v7 offset:960
    v_exp_f32 v198, v198
    v_mfma_f32_16x16x32_bf16 v[224:227], v[24:27], v[56:59], 0
    s_waitcnt lgkmcnt(6)
    v_max3_f32 v14, v220, v221, v14
    v_max3_f32 v14, v222, v223, v14
    v_mfma_f32_16x16x32_bf16 v[224:227], v[28:31], v[60:63], v[224:227]
    s_waitcnt lgkmcnt(5)
    v_cvt_pk_bf16_f32 v210, v212, v213
    v_exp_f32 v199, v199
    v_mfma_f32_16x16x32_bf16 v[224:227], v[32:35], v[64:67], v[224:227]
    s_waitcnt lgkmcnt(4)
    v_fma_f32 v214, v214, s30, v9
    v_fma_f32 v215, v215, s30, v9
    v_exp_f32 v214, v214
    v_mfma_f32_16x16x32_bf16 v[224:227], v[36:39], v[68:71], v[224:227]
    v_cvt_pk_bf16_f32 v195, v198, v199
    v_mfma_f32_16x16x32_bf16 v[240:243], v[24:27], v[72:75], 0
    s_waitcnt vmcnt(2)
    v_add_u32 v7, 84480, v3
    s_barrier
    ds_read_b64_tr_b16 v[24:25], v7 offset:0
    v_max3_f32 v15, v236, v237, v15
    v_max3_f32 v15, v238, v239, v15
    v_mfma_f32_16x16x32_bf16 v[240:243], v[28:31], v[76:79], v[240:243]
    ds_read_b64_tr_b16 v[26:27], v7 offset:256
    v_exp_f32 v215, v215
    v_mfma_f32_16x16x32_bf16 v[240:243], v[32:35], v[80:83], v[240:243]
    ds_read_b64_tr_b16 v[28:29], v7 offset:512
    v_cvt_pk_bf16_f32 v211, v214, v215
    v_mfma_f32_16x16x32_bf16 v[240:243], v[36:39], v[84:87], v[240:243]
    s_waitcnt lgkmcnt(6)
    ds_read_b64_tr_b16 v[30:31], v7 offset:768
    v_mfma_f32_16x16x32_bf16 v[228:231], v[40:43], v[56:59], 0
    s_waitcnt lgkmcnt(6)
    ds_read_b64_tr_b16 v[32:33], v7 offset:32
    v_max3_f32 v14, v224, v225, v14
    v_max3_f32 v14, v226, v227, v14
    v_mfma_f32_16x16x32_bf16 v[228:231], v[44:47], v[60:63], v[228:231]
    s_waitcnt lgkmcnt(6)
    ds_read_b64_tr_b16 v[34:35], v7 offset:288
    s_add_u32 m0, s32, 42240
    s_add_u32 s34, s36, 8192
    buffer_load_dwordx4 v1, s[16:19], s34 offen nt lds
    v_mfma_f32_16x16x32_bf16 v[228:231], v[48:51], v[64:67], v[228:231]
    s_waitcnt lgkmcnt(6)
    ds_read_b64_tr_b16 v[36:37], v7 offset:544
    v_mfma_f32_16x16x32_bf16 v[228:231], v[52:55], v[68:71], v[228:231]
    ds_read_b64_tr_b16 v[38:39], v7 offset:800
    v_mfma_f32_16x16x32_bf16 v[244:247], v[40:43], v[72:75], 0
    ds_read_b64_tr_b16 v[40:41], v7 offset:64
    v_max3_f32 v15, v240, v241, v15
    v_max3_f32 v15, v242, v243, v15
    v_mfma_f32_16x16x32_bf16 v[244:247], v[44:47], v[76:79], v[244:247]
    ds_read_b64_tr_b16 v[42:43], v7 offset:320
    v_mfma_f32_16x16x32_bf16 v[244:247], v[48:51], v[80:83], v[244:247]
    ds_read_b64_tr_b16 v[44:45], v7 offset:576
    v_mfma_f32_16x16x32_bf16 v[244:247], v[52:55], v[84:87], v[244:247]
    ds_read_b64_tr_b16 v[46:47], v7 offset:832
    s_cmp_eq_u32 s29, 0
    s_cbranch_scc1 L_nr4
    s_call_b64 s[40:41], L_rescale
L_nr4:
    v_mfma_f32_16x16x32_bf16 v[248:251], v[20:23], v[184:187], v[248:251]
    ds_read_b64_tr_b16 v[48:49], v7 offset:96
    v_max3_f32 v14, v228, v229, v14
    v_max3_f32 v14, v230, v231, v14
    v_mfma_f32_16x16x32_bf16 v[248:251], v[20:23], v[192:195], v[248:251]
    ds_read_b64_tr_b16 v[50:51], v7 offset:352
    v_max3_f32 v15, v244, v245, v15
    v_max3_f32 v15, v246, v247, v15
    v_mfma_f32_16x16x32_bf16 v[252:255], v[20:23], v[200:203], v[252:255]
    ds_read_b64_tr_b16 v[52:53], v7 offset:608
    s_waitcnt vmcnt(2)
    s_add_u32 m0, s37, 7392
    s_add_u32 s34, s39, 3584
    buffer_load_dwordx4 v0, s[12:15], s34 offen nt lds
    v_mfma_f32_16x16x32_bf16 v[252:255], v[20:23], v[208:211], v[252:255]
    s_waitcnt lgkmcnt(11)
    ds_read_b64_tr_b16 v[54:55], v7 offset:864
    v_cmp_gt_f32 vcc, v14, v10
    v_cmp_gt_f32 s[42:43], v15, v11
    s_nop 3
    s_or_b64 s[42:43], s[42:43], vcc
    s_cbranch_scc0 L_nr5
    s_call_b64 s[40:41], L_newmax
L_nr5:
    v_fma_f32 v216, v216, s30, v8
    v_fma_f32 v217, v217, s30, v8
    v_mfma_f32_16x16x32_bf16 v[120:123], v[24:27], v[184:187], v[120:123]
    v_exp_f32 v216, v216
    v_exp_f32 v217, v217
    v_mfma_f32_16x16x32_bf16 v[120:123], v[28:31], v[192:195], v[120:123]
    v_fma_f32 v232, v232, s30, v9
    v_fma_f32 v233, v233, s30, v9
    v_mfma_f32_16x16x32_bf16 v[152:155], v[24:27], v[200:203], v[152:155]
    ds_read_b64_tr_b16 v[24:25], v7 offset:128
    v_exp_f32 v232, v232
    v_mfma_f32_16x16x32_bf16 v[152:155], v[28:31], v[208:211], v[152:155]
    s_waitcnt lgkmcnt(9)
    ds_read_b64_tr_b16 v[26:27], v7 offset:384
    v_cvt_pk_bf16_f32 v216, v216, v217
    v_exp_f32 v233, v233
    v_mfma_f32_16x16x32_bf16 v[124:127], v[32:35], v[184:187], v[124:127]
    ds_read_b64_tr_b16 v[28:29], v7 offset:640
    v_fma_f32 v218, v218, s30, v8
    v_fma_f32 v219, v219, s30, v8
    v_mfma_f32_16x16x32_bf16 v[124:127], v[36:39], v[192:195], v[124:127]
    ds_read_b64_tr_b16 v[30:31], v7 offset:896
    v_exp_f32 v218, v218
    v_mfma_f32_16x16x32_bf16 v[156:159], v[32:35], v[200:203], v[156:159]
    ds_read_b64_tr_b16 v[32:33], v7 offset:160
    v_cvt_pk_bf16_f32 v232, v232, v233
    v_exp_f32 v219, v219
    v_mfma_f32_16x16x32_bf16 v[156:159], v[36:39], v[208:211], v[156:159]
    s_waitcnt lgkmcnt(9)
    ds_read_b64_tr_b16 v[34:35], v7 offset:416
    v_fma_f32 v234, v234, s30, v9
    v_mfma_f32_16x16x32_bf16 v[128:131], v[40:43], v[184:187], v[128:131]
    ds_read_b64_tr_b16 v[36:37], v7 offset:672
    s_waitcnt vmcnt(2)
    s_add_u32 m0, s32, 50688
    s_add_u32 s34, s35, 49152
    buffer_load_dwordx4 v1, s[20:23], s34 offen nt lds
    v_mfma_f32_16x16x32_bf16 v[128:131], v[44:47], v[192:195], v[128:131]
    ds_read_b64_tr_b16 v[38:39], v7 offset:928
    v_fma_f32 v235, v235, s30, v9
    v_exp_f32 v234, v234
    v_mfma_f32_16x16x32_bf16 v[160:163], v[40:43], v[200:203], v[160:163]
    ds_read_b64_tr_b16 v[40:41], v7 offset:192
    v_cvt_pk_bf16_f32 v217, v218, v219
    v_mfma_f32_16x16x32_bf16 v[160:163], v[44:47], v[208:211], v[160:163]
    s_waitcnt lgkmcnt(9)
    ds_read_b64_tr_b16 v[42:43], v7 offset:448
    v_exp_f32 v235, v235
    v_fma_f32 v220, v220, s30, v8
    v_mfma_f32_16x16x32_bf16 v[132:135], v[48:51], v[184:187], v[132:135]
    ds_read_b64_tr_b16 v[44:45], v7 offset:704
    v_fma_f32 v221, v221, s30, v8
    v_exp_f32 v220, v220
    v_mfma_f32_16x16x32_bf16 v[132:135], v[52:55], v[192:195], v[132:135]
    ds_read_b64_tr_b16 v[46:47], v7 offset:960
    v_cvt_pk_bf16_f32 v233, v234, v235
    v_mfma_f32_16x16x32_bf16 v[164:167], v[48:51], v[200:203], v[164:167]
    ds_read_b64_tr_b16 v[48:49], v7 offset:224
    v_exp_f32 v221, v221
    v_mfma_f32_16x16x32_bf16 v[164:167], v[52:55], v[208:211], v[164:167]
    s_waitcnt lgkmcnt(9)
    ds_read_b64_tr_b16 v[50:51], v7 offset:480
    v_fma_f32 v236, v236, s30, v9
    v_fma_f32 v237, v237, s30, v9
    v_mfma_f32_16x16x32_bf16 v[136:139], v[24:27], v[184:187], v[136:139]
    ds_read_b64_tr_b16 v[52:53], v7 offset:736
    v_exp_f32 v236, v236
    v_cvt_pk_bf16_f32 v218, v220, v221
    v_mfma_f32_16x16x32_bf16 v[136:139], v[28:31], v[192:195], v[136:139]
    ds_read_b64_tr_b16 v[54:55], v7 offset:992
    v_exp_f32 v237, v237
    v_mfma_f32_16x16x32_bf16 v[168:171], v[24:27], v[200:203], v[168:171]
    s_waitcnt vmcnt(2)
    v_add_u32 v7, 101376, v2
    s_barrier
    ds_read_b128 v[24:27], v7 offset:0
    v_fma_f32 v222, v222, s30, v8
    v_fma_f32 v223, v223, s30, v8
    v_mfma_f32_16x16x32_bf16 v[168:171], v[28:31], v[208:211], v[168:171]
    s_waitcnt lgkmcnt(9)
    ds_read_b128 v[28:31], v7 offset:64
    v_exp_f32 v222, v222
    v_mfma_f32_16x16x32_bf16 v[140:143], v[32:35], v[184:187], v[140:143]
    v_cvt_pk_bf16_f32 v234, v236, v237
    v_exp_f32 v223, v223
    v_mfma_f32_16x16x32_bf16 v[140:143], v[36:39], v[192:195], v[140:143]
    s_add_u32 m0, s32, 59136
    s_add_u32 s34, s35, 57344
    buffer_load_dwordx4 v1, s[20:23], s34 offen nt lds
    v_fma_f32 v238, v238, s30, v9
    v_mfma_f32_16x16x32_bf16 v[172:175], v[32:35], v[200:203], v[172:175]
    ds_read_b128 v[32:35], v7 offset:128
    v_fma_f32 v239, v239, s30, v9
    v_exp_f32 v238, v238
    v_mfma_f32_16x16x32_bf16 v[172:175], v[36:39], v[208:211], v[172:175]
    s_waitcnt lgkmcnt(7)
    ds_read_b128 v[36:39], v7 offset:192
    v_cvt_pk_bf16_f32 v219, v222, v223
    v_mfma_f32_16x16x32_bf16 v[144:147], v[40:43], v[184:187], v[144:147]
    ds_read_b128 v[56:59], v4 offset:0
    ds_read_b128 v[60:63], v4 offset:64
    ds_read_b128 v[64:67], v4 offset:128
    ds_read_b128 v[68:71], v4 offset:192
    s_waitcnt vmcnt(2)
    ds_read_b128 v[72:75], v4 offset:4224
    ds_read_b128 v[76:79], v4 offset:4288
    ds_read_b128 v[80:83], v4 offset:4352
    ds_read_b128 v[84:87], v4 offset:4416
    v_exp_f32 v239, v239
    v_mfma_f32_16x16x32_bf16 v[144:147], v[44:47], v[192:195], v[144:147]
    v_fma_f32 v224, v224, s30, v8
    v_fma_f32 v225, v225, s30, v8
    v_mfma_f32_16x16x32_bf16 v[176:179], v[40:43], v[200:203], v[176:179]
    ds_read_b128 v[40:43], v7 offset:256
    v_exp_f32 v224, v224
    v_mfma_f32_16x16x32_bf16 v[176:179], v[44:47], v[208:211], v[176:179]
    s_waitcnt lgkmcnt(13)
    ds_read_b128 v[44:47], v7 offset:320
    v_cvt_pk_bf16_f32 v235, v238, v239
    v_exp_f32 v225, v225
    v_mfma_f32_16x16x32_bf16 v[148:151], v[48:51], v[184:187], v[148:151]
    v_fma_f32 v240, v240, s30, v9
    v_fma_f32 v241, v241, s30, v9
    v_mfma_f32_16x16x32_bf16 v[148:151], v[52:55], v[192:195], v[148:151]
    v_exp_f32 v240, v240
    v_cvt_pk_bf16_f32 v224, v224, v225
    v_exp_f32 v241, v241
    v_mfma_f32_16x16x32_bf16 v[180:183], v[48:51], v[200:203], v[180:183]
    ds_read_b128 v[48:51], v7 offset:384
    v_fma_f32 v226, v226, s30, v8
    v_mfma_f32_16x16x32_bf16 v[180:183], v[52:55], v[208:211], v[180:183]
    ds_read_b128 v[52:55], v7 offset:448
    v_fma_f32 v227, v227, s30, v8
    v_exp_f32 v226, v226
    v_cvt_pk_bf16_f32 v240, v240, v241
    v_exp_f32 v227, v227
    s_waitcnt lgkmcnt(8)
    s_waitcnt lgkmcnt(4)
    v_mfma_f32_16x16x32_bf16 v[184:187], v[24:27], v[56:59], 0
    v_fma_f32 v242, v242, s30, v9
    v_fma_f32 v243, v243, s30, v9
    v_exp_f32 v242, v242
    v_mfma_f32_16x16x32_bf16 v[184:187], v[28:31], v[60:63], v[184:187]
    v_cvt_pk_bf16_f32 v225, v226, v227
    v_mfma_f32_16x16x32_bf16 v[184:187], v[32:35], v[64:67], v[184:187]
    v_exp_f32 v243, v243
    v_fma_f32 v228, v228, s30, v8
    v_mfma_f32_16x16x32_bf16 v[184:187], v[36:39], v[68:71], v[184:187]
    v_fma_f32 v229, v229, s30, v8
    v_exp_f32 v228, v228
    v_mfma_f32_16x16x32_bf16 v[200:203], v[24:27], v[72:75], 0
    s_setprio 1
    ds_read_b128 v[24:27], v7 offset:512
    v_cvt_pk_bf16_f32 v241, v242, v243
    v_mfma_f32_16x16x32_bf16 v[200:203], v[28:31], v[76:79], v[200:203]
    ds_read_b128 v[28:31], v7 offset:576
    v_exp_f32 v229, v229
    v_mfma_f32_16x16x32_bf16 v[200:203], v[32:35], v[80:83], v[200:203]
    ds_read_b128 v[32:35], v7 offset:640
    v_fma_f32 v244, v244, s30, v9
    v_mfma_f32_16x16x32_bf16 v[200:203], v[36:39], v[84:87], v[200:203]
    s_waitcnt lgkmcnt(6)
    ds_read_b128 v[36:39], v7 offset:704
    v_fma_f32 v245, v245, s30, v9
    v_mfma_f32_16x16x32_bf16 v[188:191], v[40:43], v[56:59], 0
    s_waitcnt lgkmcnt(6)
    v_max_f32 v14, v184, v185
    v_max3_f32 v14, v186, v187, v14
    v_exp_f32 v244, v244
    v_mfma_f32_16x16x32_bf16 v[188:191], v[44:47], v[60:63], v[188:191]
    s_waitcnt lgkmcnt(5)
    v_cvt_pk_bf16_f32 v226, v228, v229
    v_mfma_f32_16x16x32_bf16 v[188:191], v[48:51], v[64:67], v[188:191]
    s_waitcnt lgkmcnt(4)
    v_exp_f32 v245, v245
    v_fma_f32 v230, v230, s30, v8
    v_mfma_f32_16x16x32_bf16 v[188:191], v[52:55], v[68:71], v[188:191]
    v_fma_f32 v231, v231, s30, v8
    v_exp_f32 v230, v230
    v_mfma_f32_16x16x32_bf16 v[204:207], v[40:43], v[72:75], 0
    s_setprio 0
    ds_read_b128 v[40:43], v7 offset:768
    s_add_u32 m0, s32, 67584
    s_add_u32 s34, s36, 16384
    buffer_load_dwordx4 v1, s[16:19], s34 offen nt lds
    v_mfma_f32_16x16x32_bf16 v[204:207], v[44:47], v[76:79], v[204:207]
    ds_read_b128 v[44:47], v7 offset:832
    v_mfma_f32_16x16x32_bf16 v[204:207], v[48:51], v[80:83], v[204:207]
    ds_read_b128 v[48:51], v7 offset:896
    v_max_f32 v15, v200, v201
    v_max3_f32 v15, v202, v203, v15
    v_mfma_f32_16x16x32_bf16 v[204:207], v[52:55], v[84:87], v[204:207]
    s_waitcnt lgkmcnt(6)
    ds_read_b128 v[52:55], v7 offset:960
    v_cvt_pk_bf16_f32 v242, v244, v245
    v_mfma_f32_16x16x32_bf16 v[192:195], v[24:27], v[56:59], 0
    s_waitcnt lgkmcnt(6)
    v_max3_f32 v14, v188, v189, v14
    v_max3_f32 v14, v190, v191, v14
    v_exp_f32 v231, v231
    v_mfma_f32_16x16x32_bf16 v[192:195], v[28:31], v[60:63], v[192:195]
    s_waitcnt lgkmcnt(5)
    v_fma_f32 v246, v246, s30, v9
    v_mfma_f32_16x16x32_bf16 v[192:195], v[32:35], v[64:67], v[192:195]
    s_waitcnt lgkmcnt(4)
    v_fma_f32 v247, v247, s30, v9
    v_exp_f32 v246, v246
    v_mfma_f32_16x16x32_bf16 v[192:195], v[36:39], v[68:71], v[192:195]
    v_cvt_pk_bf16_f32 v227, v230, v231
    v_exp_f32 v247, v247
    v_mfma_f32_16x16x32_bf16 v[208:211], v[24:27], v[72:75], 0
    s_setprio 3
    s_waitcnt vmcnt(1)
    v_add_u32 v7, 118272, v3
    s_barrier
    ds_read_b64_tr_b16 v[24:25], v7 offset:0
    v_max3_f32 v15, v204, v205, v15
    v_mfma_f32_16x16x32_bf16 v[208:211], v[28:31], v[76:79], v[208:211]
    ds_read_b64_tr_b16 v[26:27], v7 offset:256
    v_max3_f32 v15, v206, v207, v15
    v_mfma_f32_16x16x32_bf16 v[208:211], v[32:35], v[80:83], v[208:211]
    ds_read_b64_tr_b16 v[28:29], v7 offset:512
    v_cvt_pk_bf16_f32 v243, v246, v247
    v_mfma_f32_16x16x32_bf16 v[208:211], v[36:39], v[84:87], v[208:211]
    s_waitcnt lgkmcnt(6)
    ds_read_b64_tr_b16 v[30:31], v7 offset:768
    v_mfma_f32_16x16x32_bf16 v[196:199], v[40:43], v[56:59], 0
    s_waitcnt lgkmcnt(6)
    ds_read_b64_tr_b16 v[32:33], v7 offset:32
    v_max3_f32 v14, v192, v193, v14
    v_max3_f32 v14, v194, v195, v14
    v_mfma_f32_16x16x32_bf16 v[196:199], v[44:47], v[60:63], v[196:199]
    s_waitcnt lgkmcnt(6)
    ds_read_b64_tr_b16 v[34:35], v7 offset:288
    s_add_u32 m0, s32, 76032
    s_add_u32 s34, s36, 24576
    buffer_load_dwordx4 v1, s[16:19], s34 offen nt lds
    v_mfma_f32_16x16x32_bf16 v[196:199], v[48:51], v[64:67], v[196:199]
    s_waitcnt lgkmcnt(6)
    ds_read_b64_tr_b16 v[36:37], v7 offset:544
    v_mfma_f32_16x16x32_bf16 v[196:199], v[52:55], v[68:71], v[196:199]
    ds_read_b64_tr_b16 v[38:39], v7 offset:800
    v_mfma_f32_16x16x32_bf16 v[212:215], v[40:43], v[72:75], 0
    s_setprio 2
    ds_read_b64_tr_b16 v[40:41], v7 offset:64
    v_max3_f32 v15, v208, v209, v15
    v_max3_f32 v15, v210, v211, v15
    v_mfma_f32_16x16x32_bf16 v[212:215], v[44:47], v[76:79], v[212:215]
    ds_read_b64_tr_b16 v[42:43], v7 offset:320
    v_mfma_f32_16x16x32_bf16 v[212:215], v[48:51], v[80:83], v[212:215]
    ds_read_b64_tr_b16 v[44:45], v7 offset:576
    v_mfma_f32_16x16x32_bf16 v[212:215], v[52:55], v[84:87], v[212:215]
    ds_read_b64_tr_b16 v[46:47], v7 offset:832
    s_cmp_eq_u32 s29, 0
    s_cbranch_scc1 L_nr6
    s_call_b64 s[40:41], L_rescale
L_nr6:
    v_mfma_f32_16x16x32_bf16 v[248:251], v[20:23], v[216:219], v[248:251]
    ds_read_b64_tr_b16 v[48:49], v7 offset:96
    v_max3_f32 v14, v196, v197, v14
    v_max3_f32 v14, v198, v199, v14
    v_max3_f32 v15, v212, v213, v15
    v_max3_f32 v15, v214, v215, v15
    v_mfma_f32_16x16x32_bf16 v[248:251], v[20:23], v[224:227], v[248:251]
    ds_read_b64_tr_b16 v[50:51], v7 offset:352
    v_mov_b32 v12, v14
    v_mov_b32 v13, v15
    s_nop 0
    v_permlane32_swap_b32 v14, v12
    v_permlane32_swap_b32 v15, v13
    v_max_f32 v14, v14, v12
    v_mfma_f32_16x16x32_bf16 v[252:255], v[20:23], v[232:235], v[252:255]
    ds_read_b64_tr_b16 v[52:53], v7 offset:608
    v_max_f32 v15, v15, v13
    v_mov_b32 v12, v14
    v_mov_b32 v13, v15
    s_nop 0
    v_permlane16_swap_b32 v14, v12
    v_mfma_f32_16x16x32_bf16 v[252:255], v[20:23], v[240:243], v[252:255]
    s_waitcnt lgkmcnt(11)
    ds_read_b64_tr_b16 v[54:55], v7 offset:864
    v_permlane16_swap_b32 v15, v13
    v_max_f32 v14, v14, v12
    v_max_f32 v15, v15, v13
    v_mul_f32 v8, s31, v14
    v_mfma_f32_16x16x32_bf16 v[120:123], v[24:27], v[216:219], v[120:123]
    s_setprio 1
    s_add_u32 m0, s32, 0
    s_add_u32 s34, s36, 0
    buffer_load_dwordx4 v1, s[20:23], s34 offen nt lds
    v_mul_f32 v9, s31, v15
    v_add_f32 v10, s33, v14
    v_add_f32 v11, s33, v15
    v_mfma_f32_16x16x32_bf16 v[120:123], v[28:31], v[224:227], v[120:123]
    v_fma_f32 v184, v184, s30, v8
    v_fma_f32 v185, v185, s30, v8
    v_exp_f32 v184, v184
    v_exp_f32 v185, v185
    v_mfma_f32_16x16x32_bf16 v[152:155], v[24:27], v[232:235], v[152:155]
    ds_read_b64_tr_b16 v[24:25], v7 offset:128
    v_fma_f32 v200, v200, s30, v9
    v_fma_f32 v201, v201, s30, v9
    v_exp_f32 v200, v200
    v_mfma_f32_16x16x32_bf16 v[152:155], v[28:31], v[240:243], v[152:155]
    s_waitcnt lgkmcnt(9)
    ds_read_b64_tr_b16 v[26:27], v7 offset:384
    v_cvt_pk_bf16_f32 v184, v184, v185
    v_exp_f32 v201, v201
    v_mfma_f32_16x16x32_bf16 v[124:127], v[32:35], v[216:219], v[124:127]
    ds_read_b64_tr_b16 v[28:29], v7 offset:640
    v_fma_f32 v186, v186, s30, v8
    v_fma_f32 v187, v187, s30, v8
    v_exp_f32 v186, v186
    v_rcp_f32 v16, v248
    v_mfma_f32_16x16x32_bf16 v[124:127], v[36:39], v[224:227], v[124:127]
    ds_read_b64_tr_b16 v[30:31], v7 offset:896
    v_rcp_f32 v17, v252
    v_mul_f32 v120, v120, v16
    v_mfma_f32_16x16x32_bf16 v[156:159], v[32:35], v[232:235], v[156:159]
    ds_read_b64_tr_b16 v[32:33], v7 offset:160
    v_mul_f32 v121, v121, v16
    v_mul_f32 v122, v122, v16
    v_mul_f32 v123, v123, v16
    v_cvt_pk_bf16_f32 v120, v120, v121
    v_mfma_f32_16x16x32_bf16 v[156:159], v[36:39], v[240:243], v[156:159]
    s_waitcnt lgkmcnt(9)
    ds_read_b64_tr_b16 v[34:35], v7 offset:416
    v_cvt_pk_bf16_f32 v121, v122, v123
    ds_write_b64 v5, v[120:121] offset:0
    v_mul_f32 v152, v152, v17
    v_mul_f32 v153, v153, v17
    v_mfma_f32_16x16x32_bf16 v[128:131], v[40:43], v[216:219], v[128:131]
    ds_read_b64_tr_b16 v[36:37], v7 offset:672
    s_waitcnt vmcnt(2)
    s_add_u32 m0, s32, 8448
    s_add_u32 s34, s36, 8192
    buffer_load_dwordx4 v1, s[20:23], s34 offen nt lds
    v_mul_f32 v154, v154, v17
    v_mul_f32 v155, v155, v17
    v_mfma_f32_16x16x32_bf16 v[128:131], v[44:47], v[224:227], v[128:131]
    s_setprio 0
    ds_read_b64_tr_b16 v[38:39], v7 offset:928
    v_cvt_pk_bf16_f32 v152, v152, v153
    v_cvt_pk_bf16_f32 v153, v154, v155
    ds_write_b64 v5, v[152:153] offset:512
    v_mul_f32 v124, v124, v16
    v_mfma_f32_16x16x32_bf16 v[160:163], v[40:43], v[232:235], v[160:163]
    ds_read_b64_tr_b16 v[40:41], v7 offset:192
    v_mul_f32 v125, v125, v16
    v_mul_f32 v126, v126, v16
    v_mul_f32 v127, v127, v16
    v_cvt_pk_bf16_f32 v124, v124, v125
    v_cvt_pk_bf16_f32 v125, v126, v127
    v_mfma_f32_16x16x32_bf16 v[160:163], v[44:47], v[240:243], v[160:163]
    s_waitcnt lgkmcnt(11)
    ds_read_b64_tr_b16 v[42:43], v7 offset:448
    ds_write_b64 v5, v[124:125] offset:32
    v_mul_f32 v156, v156, v17
    v_mul_f32 v157, v157, v17
    v_mul_f32 v158, v158, v17
    v_mfma_f32_16x16x32_bf16 v[132:135], v[48:51], v[216:219], v[132:135]
    ds_read_b64_tr_b16 v[44:45], v7 offset:704
    v_mul_f32 v159, v159, v17
    v_cvt_pk_bf16_f32 v156, v156, v157
    v_cvt_pk_bf16_f32 v157, v158, v159
    ds_write_b64 v5, v[156:157] offset:544
    v_mfma_f32_16x16x32_bf16 v[132:135], v[52:55], v[224:227], v[132:135]
    ds_read_b64_tr_b16 v[46:47], v7 offset:960
    v_mul_f32 v128, v128, v16
    v_mul_f32 v129, v129, v16
    v_mul_f32 v130, v130, v16
    v_mul_f32 v131, v131, v16
    v_cvt_pk_bf16_f32 v128, v128, v129
    v_mfma_f32_16x16x32_bf16 v[164:167], v[48:51], v[232:235], v[164:167]
    ds_read_b64_tr_b16 v[48:49], v7 offset:224
    v_cvt_pk_bf16_f32 v129, v130, v131
    ds_write_b64 v5, v[128:129] offset:64
    v_mul_f32 v160, v160, v17
    v_mul_f32 v161, v161, v17
    v_mfma_f32_16x16x32_bf16 v[164:167], v[52:55], v[240:243], v[164:167]
    s_waitcnt lgkmcnt(14)
    ds_read_b64_tr_b16 v[50:51], v7 offset:480
    v_mul_f32 v162, v162, v17
    v_mul_f32 v163, v163, v17
    v_cvt_pk_bf16_f32 v160, v160, v161
    v_cvt_pk_bf16_f32 v161, v162, v163
    v_mfma_f32_16x16x32_bf16 v[136:139], v[24:27], v[216:219], v[136:139]
    ds_read_b64_tr_b16 v[52:53], v7 offset:736
    s_waitcnt vmcnt(2)
    s_add_u32 m0, s32, 16896
    s_add_u32 s34, s36, 32768
    buffer_load_dwordx4 v1, s[16:19], s34 offen nt lds
    ds_write_b64 v5, v[160:161] offset:576
    v_mul_f32 v132, v132, v16
    v_mfma_f32_16x16x32_bf16 v[136:139], v[28:31], v[224:227], v[136:139]
    ds_read_b64_tr_b16 v[54:55], v7 offset:992
    v_mul_f32 v133, v133, v16
    v_mul_f32 v134, v134, v16
    v_mul_f32 v135, v135, v16
    v_cvt_pk_bf16_f32 v132, v132, v133
    v_mfma_f32_16x16x32_bf16 v[168:171], v[24:27], v[232:235], v[168:171]
    s_setprio 3
    v_add_u32 v7, 135168, v2
    s_barrier
    ds_read_b128 v[24:27], v7 offset:0
    v_cvt_pk_bf16_f32 v133, v134, v135
    ds_write_b64 v5, v[132:133] offset:96
    v_mul_f32 v164, v164, v17
    v_mul_f32 v165, v165, v17
    v_mfma_f32_16x16x32_bf16 v[168:171], v[28:31], v[240:243], v[168:171]
    s_waitcnt lgkmcnt(15)
    ds_read_b128 v[28:31], v7 offset:64
    v_mul_f32 v166, v166, v17
    v_mul_f32 v167, v167, v17
    v_cvt_pk_bf16_f32 v164, v164, v165
    v_cvt_pk_bf16_f32 v165, v166, v167
    ds_write_b64 v5, v[164:165] offset:608
    v_mfma_f32_16x16x32_bf16 v[140:143], v[32:35], v[216:219], v[140:143]
    v_mul_f32 v136, v136, v16
    v_mul_f32 v137, v137, v16
    v_mul_f32 v138, v138, v16
    v_mul_f32 v139, v139, v16
    v_cvt_pk_bf16_f32 v136, v136, v137
    v_mfma_f32_16x16x32_bf16 v[140:143], v[36:39], v[224:227], v[140:143]
    v_cvt_pk_bf16_f32 v137, v138, v139
    ds_write_b64 v5, v[136:137] offset:128
    v_mfma_f32_16x16x32_bf16 v[172:175], v[32:35], v[232:235], v[172:175]
    ds_read_b128 v[32:35], v7 offset:128
    v_mul_f32 v168, v168, v17
    v_mul_f32 v169, v169, v17
    v_mul_f32 v170, v170, v17
    v_mul_f32 v171, v171, v17
    v_cvt_pk_bf16_f32 v168, v168, v169
    v_cvt_pk_bf16_f32 v169, v170, v171
    ds_write_b64 v5, v[168:169] offset:640
    v_mfma_f32_16x16x32_bf16 v[172:175], v[36:39], v[240:243], v[172:175]
    s_waitcnt lgkmcnt(13)
    ds_read_b128 v[36:39], v7 offset:192
    v_mfma_f32_16x16x32_bf16 v[144:147], v[40:43], v[216:219], v[144:147]
    s_waitcnt vmcnt(2)
    s_add_u32 m0, s32, 25344
    s_add_u32 s34, s36, 40960
    buffer_load_dwordx4 v1, s[16:19], s34 offen nt lds
    v_mul_f32 v140, v140, v16
    v_mul_f32 v141, v141, v16
    v_mul_f32 v142, v142, v16
    v_mul_f32 v143, v143, v16
    v_cvt_pk_bf16_f32 v140, v140, v141
    v_cvt_pk_bf16_f32 v141, v142, v143
    ds_write_b64 v5, v[140:141] offset:160
    v_mfma_f32_16x16x32_bf16 v[144:147], v[44:47], v[224:227], v[144:147]
    v_mfma_f32_16x16x32_bf16 v[176:179], v[40:43], v[232:235], v[176:179]
    ds_read_b128 v[40:43], v7 offset:256
    v_mul_f32 v172, v172, v17
    v_mul_f32 v173, v173, v17
    v_mul_f32 v174, v174, v17
    v_mul_f32 v175, v175, v17
    v_cvt_pk_bf16_f32 v172, v172, v173
    v_cvt_pk_bf16_f32 v173, v174, v175
    ds_write_b64 v5, v[172:173] offset:672
    v_mfma_f32_16x16x32_bf16 v[176:179], v[44:47], v[240:243], v[176:179]
    s_waitcnt lgkmcnt(11)
    s_setprio 2
    ds_read_b128 v[44:47], v7 offset:320
    v_mfma_f32_16x16x32_bf16 v[148:151], v[48:51], v[216:219], v[148:151]
    v_mul_f32 v144, v144, v16
    v_mul_f32 v145, v145, v16
    v_mul_f32 v146, v146, v16
    v_mul_f32 v147, v147, v16
    v_cvt_pk_bf16_f32 v144, v144, v145
    v_cvt_pk_bf16_f32 v145, v146, v147
    ds_write_b64 v5, v[144:145] offset:192
    v_mfma_f32_16x16x32_bf16 v[148:151], v[52:55], v[224:227], v[148:151]
    v_mfma_f32_16x16x32_bf16 v[180:183], v[48:51], v[232:235], v[180:183]
    ds_read_b128 v[48:51], v7 offset:384
    v_mul_f32 v176, v176, v17
    v_mul_f32 v177, v177, v17
    v_mul_f32 v178, v178, v17
    v_mul_f32 v179, v179, v17
    v_cvt_pk_bf16_f32 v176, v176, v177
    v_cvt_pk_bf16_f32 v177, v178, v179
    ds_write_b64 v5, v[176:177] offset:704
    v_mfma_f32_16x16x32_bf16 v[180:183], v[52:55], v[240:243], v[180:183]
    ds_read_b128 v[52:55], v7 offset:448
    s_waitcnt lgkmcnt(15)
    v_mfma_f32_16x16x32_bf16 v[216:219], v[24:27], v[56:59], 0
    s_waitcnt lgkmcnt(13)
    v_mul_f32 v148, v148, v16
    v_mul_f32 v149, v149, v16
    v_mul_f32 v150, v150, v16
    v_mul_f32 v151, v151, v16
    v_cvt_pk_bf16_f32 v148, v148, v149
    v_mfma_f32_16x16x32_bf16 v[216:219], v[28:31], v[60:63], v[216:219]
    s_waitcnt lgkmcnt(10)
    v_cvt_pk_bf16_f32 v149, v150, v151
    ds_write_b64 v5, v[148:149] offset:224
    v_mul_f32 v180, v180, v17
    v_mul_f32 v181, v181, v17
    v_mul_f32 v182, v182, v17
    v_mfma_f32_16x16x32_bf16 v[216:219], v[32:35], v[64:67], v[216:219]
    s_waitcnt lgkmcnt(9)
    v_mul_f32 v183, v183, v17
    v_cvt_pk_bf16_f32 v180, v180, v181
    v_cvt_pk_bf16_f32 v181, v182, v183
    ds_write_b64 v5, v[180:181] offset:736
    s_waitcnt lgkmcnt(0)
    ds_read_b128 v[88:91], v6 offset:0
    ds_read_b128 v[92:95], v6 offset:1040
    ds_read_b128 v[96:99], v6 offset:2080
    v_mfma_f32_16x16x32_bf16 v[216:219], v[36:39], v[68:71], v[216:219]
    ds_read_b128 v[100:103], v6 offset:3120
    ds_read_b128 v[104:107], v6 offset:4160
    ds_read_b128 v[108:111], v6 offset:5200
    ds_read_b128 v[112:115], v6 offset:6240
    ds_read_b128 v[116:119], v6 offset:7280
    v_cvt_pk_bf16_f32 v200, v200, v201
    v_exp_f32 v187, v187
    v_fma_f32 v202, v202, s30, v9
    v_mfma_f32_16x16x32_bf16 v[232:235], v[24:27], v[72:75], 0
    s_setprio 1
    ds_read_b128 v[24:27], v7 offset:512
    s_add_u32 m0, s32, 33792
    s_add_u32 s34, s36, 16384
    buffer_load_dwordx4 v1, s[20:23], s34 offen nt lds
    v_fma_f32 v203, v203, s30, v9
    v_exp_f32 v202, v202
    v_mfma_f32_16x16x32_bf16 v[232:235], v[28:31], v[76:79], v[232:235]
    ds_read_b128 v[28:31], v7 offset:576
    v_cvt_pk_bf16_f32 v185, v186, v187
    v_exp_f32 v203, v203
    v_mfma_f32_16x16x32_bf16 v[232:235], v[32:35], v[80:83], v[232:235]
    ds_read_b128 v[32:35], v7 offset:640
    v_fma_f32 v188, v188, s30, v8
    v_fma_f32 v189, v189, s30, v8
    v_exp_f32 v188, v188
    v_mfma_f32_16x16x32_bf16 v[232:235], v[36:39], v[84:87], v[232:235]
    ds_read_b128 v[36:39], v7 offset:704
    v_cvt_pk_bf16_f32 v201, v202, v203
    v_exp_f32 v189, v189
    v_fma_f32 v204, v204, s30, v9
    v_mfma_f32_16x16x32_bf16 v[220:223], v[40:43], v[56:59], 0
    v_max_f32 v14, v216, v217
    v_max3_f32 v14, v218, v219, v14
    v_fma_f32 v205, v205, s30, v9
    v_exp_f32 v204, v204
    v_mfma_f32_16x16x32_bf16 v[220:223], v[44:47], v[60:63], v[220:223]
    v_cvt_pk_bf16_f32 v186, v188, v189
    v_exp_f32 v205, v205
    v_fma_f32 v190, v190, s30, v8
    v_fma_f32 v191, v191, s30, v8
    v_mfma_f32_16x16x32_bf16 v[220:223], v[48:51], v[64:67], v[220:223]
    v_exp_f32 v190, v190
    v_cvt_pk_bf16_f32 v202, v204, v205
    v_exp_f32 v191, v191
    v_mfma_f32_16x16x32_bf16 v[220:223], v[52:55], v[68:71], v[220:223]
    v_fma_f32 v206, v206, s30, v9
    v_fma_f32 v207, v207, s30, v9
    v_exp_f32 v206, v206
    v_cvt_pk_bf16_f32 v187, v190, v191
    v_exp_f32 v207, v207
    v_mfma_f32_16x16x32_bf16 v[236:239], v[40:43], v[72:75], 0
    s_setprio 0
    ds_read_b128 v[40:43], v7 offset:768
    v_max_f32 v15, v232, v233
    v_max3_f32 v15, v234, v235, v15
    v_fma_f32 v192, v192, s30, v8
    v_mfma_f32_16x16x32_bf16 v[236:239], v[44:47], v[76:79], v[236:239]
    ds_read_b128 v[44:47], v7 offset:832
    v_fma_f32 v193, v193, s30, v8
    v_exp_f32 v192, v192
    v_cvt_pk_bf16_f32 v203, v206, v207
    v_mfma_f32_16x16x32_bf16 v[236:239], v[48:51], v[80:83], v[236:239]
    ds_read_b128 v[48:51], v7 offset:896
    v_exp_f32 v193, v193
    v_fma_f32 v208, v208, s30, v9
    v_fma_f32 v209, v209, s30, v9
    v_mfma_f32_16x16x32_bf16 v[236:239], v[52:55], v[84:87], v[236:239]
    s_waitcnt lgkmcnt(6)
    ds_read_b128 v[52:55], v7 offset:960
    v_exp_f32 v208, v208
    v_cvt_pk_bf16_f32 v192, v192, v193
    v_exp_f32 v209, v209
    v_mfma_f32_16x16x32_bf16 v[224:227], v[24:27], v[56:59], 0
    s_waitcnt lgkmcnt(6)
    s_add_u32 m0, s32, 42240
    s_add_u32 s34, s36, 24576
    buffer_load_dwordx4 v1, s[20:23], s34 offen nt lds
    v_max3_f32 v14, v220, v221, v14
    v_max3_f32 v14, v222, v223, v14
    v_mfma_f32_16x16x32_bf16 v[224:227], v[28:31], v[60:63], v[224:227]
    s_waitcnt lgkmcnt(5)
    v_fma_f32 v194, v194, s30, v8
    v_fma_f32 v195, v195, s30, v8
    v_exp_f32 v194, v194
    v_cvt_pk_bf16_f32 v208, v208, v209
    v_mfma_f32_16x16x32_bf16 v[224:227], v[32:35], v[64:67], v[224:227]
    s_waitcnt lgkmcnt(4)
    v_exp_f32 v195, v195
    v_fma_f32 v210, v210, s30, v9
    v_fma_f32 v211, v211, s30, v9
    v_exp_f32 v210, v210
    v_mfma_f32_16x16x32_bf16 v[224:227], v[36:39], v[68:71], v[224:227]
    v_cvt_pk_bf16_f32 v193, v194, v195
    v_exp_f32 v211, v211
    v_fma_f32 v196, v196, s30, v8
    v_mfma_f32_16x16x32_bf16 v[240:243], v[24:27], v[72:75], 0
    s_setprio 3
    s_waitcnt vmcnt(4)
    v_add_u32 v7, 67584, v3
    s_barrier
    ds_read_b64_tr_b16 v[24:25], v7 offset:0
    v_max3_f32 v15, v236, v237, v15
    v_max3_f32 v15, v238, v239, v15
    v_fma_f32 v197, v197, s30, v8
    v_exp_f32 v196, v196
    v_mfma_f32_16x16x32_bf16 v[240:243], v[28:31], v[76:79], v[240:243]
    ds_read_b64_tr_b16 v[26:27], v7 offset:256
    v_cvt_pk_bf16_f32 v209, v210, v211
    v_exp_f32 v197, v197
    v_mfma_f32_16x16x32_bf16 v[240:243], v[32:35], v[80:83], v[240:243]
    ds_read_b64_tr_b16 v[28:29], v7 offset:512
    v_fma_f32 v212, v212, s30, v9
    v_fma_f32 v213, v213, s30, v9
    v_exp_f32 v212, v212
    v_cvt_pk_bf16_f32 v194, v196, v197
    v_mfma_f32_16x16x32_bf16 v[240:243], v[36:39], v[84:87], v[240:243]
    s_waitcnt lgkmcnt(6)
    ds_read_b64_tr_b16 v[30:31], v7 offset:768
    v_exp_f32 v213, v213
    v_fma_f32 v198, v198, s30, v8
    v_fma_f32 v199, v199, s30, v8
    v_mfma_f32_16x16x32_bf16 v[228:231], v[40:43], v[56:59], 0
    s_waitcnt lgkmcnt(6)
    ds_read_b64_tr_b16 v[32:33], v7 offset:32
    s_add_u32 s34, s38, 0
    buffer_store_dwordx4 v[88:91], v1, s[24:27], s34 offen nt
    v_max3_f32 v14, v224, v225, v14
    v_mfma_f32_16x16x32_bf16 v[228:231], v[44:47], v[60:63], v[228:231]
    s_waitcnt lgkmcnt(6)
    ds_read_b64_tr_b16 v[34:35], v7 offset:288
    v_max3_f32 v14, v226, v227, v14
    v_exp_f32 v198, v198
    v_cvt_pk_bf16_f32 v210, v212, v213
    v_mfma_f32_16x16x32_bf16 v[228:231], v[48:51], v[64:67], v[228:231]
    s_waitcnt lgkmcnt(6)
    ds_read_b64_tr_b16 v[36:37], v7 offset:544
    v_exp_f32 v199, v199
    v_fma_f32 v214, v214, s30, v9
    v_fma_f32 v215, v215, s30, v9
    v_exp_f32 v214, v214
    v_mfma_f32_16x16x32_bf16 v[228:231], v[52:55], v[68:71], v[228:231]
    ds_read_b64_tr_b16 v[38:39], v7 offset:800
    v_cvt_pk_bf16_f32 v195, v198, v199
    v_exp_f32 v215, v215
    v_mfma_f32_16x16x32_bf16 v[244:247], v[40:43], v[72:75], 0
    s_setprio 2
    ds_read_b64_tr_b16 v[40:41], v7 offset:64
    s_add_u32 m0, s32, 50688
    s_add_u32 s34, s36, 49152
    buffer_load_dwordx4 v1, s[16:19], s34 offen nt lds
    v_max3_f32 v15, v240, v241, v15
    v_mfma_f32_16x16x32_bf16 v[244:247], v[44:47], v[76:79], v[244:247]
    ds_read_b64_tr_b16 v[42:43], v7 offset:320
    v_max3_f32 v15, v242, v243, v15
    v_cvt_pk_bf16_f32 v211, v214, v215
    v_mfma_f32_16x16x32_bf16 v[244:247], v[48:51], v[80:83], v[244:247]
    ds_read_b64_tr_b16 v[44:45], v7 offset:576
    s_add_u32 s34, s38, 1024
    buffer_store_dwordx4 v[92:95], v1, s[24:27], s34 offen nt
    v_mfma_f32_16x16x32_bf16 v[244:247], v[52:55], v[84:87], v[244:247]
    ds_read_b64_tr_b16 v[46:47], v7 offset:832
    v_mfma_f32_16x16x32_bf16 v[248:251], v[20:23], v[184:187], 0
    ds_read_b64_tr_b16 v[48:49], v7 offset:96
    v_max3_f32 v14, v228, v229, v14
    v_max3_f32 v14, v230, v231, v14
    v_mfma_f32_16x16x32_bf16 v[248:251], v[20:23], v[192:195], v[248:251]
    ds_read_b64_tr_b16 v[50:51], v7 offset:352
    s_nop 0
    v_max3_f32 v15, v244, v245, v15
    v_max3_f32 v15, v246, v247, v15
    v_mfma_f32_16x16x32_bf16 v[252:255], v[20:23], v[200:203], 0
    ds_read_b64_tr_b16 v[52:53], v7 offset:608
    v_cmp_gt_f32 vcc, v14, v10
    v_cmp_gt_f32 s[42:43], v15, v11
    s_nop 3
    s_or_b64 s[42:43], s[42:43], vcc
    s_cbranch_scc0 L_nr7
    s_call_b64 s[40:41], L_newmax
L_nr7:
    v_fma_f32 v216, v216, s30, v8
    v_mfma_f32_16x16x32_bf16 v[252:255], v[20:23], v[208:211], v[252:255]
    s_waitcnt lgkmcnt(11)
    ds_read_b64_tr_b16 v[54:55], v7 offset:864
    v_fma_f32 v217, v217, s30, v8
    v_exp_f32 v216, v216
    v_mfma_f32_16x16x32_bf16 v[120:123], v[24:27], v[184:187], 0
    s_setprio 1
    v_exp_f32 v217, v217
    v_mfma_f32_16x16x32_bf16 v[120:123], v[28:31], v[192:195], v[120:123]
    v_fma_f32 v232, v232, s30, v9
    v_fma_f32 v233, v233, s30, v9
    v_exp_f32 v232, v232
    v_mfma_f32_16x16x32_bf16 v[152:155], v[24:27], v[200:203], 0
    ds_read_b64_tr_b16 v[24:25], v7 offset:128
    v_cvt_pk_bf16_f32 v216, v216, v217
    v_mfma_f32_16x16x32_bf16 v[152:155], v[28:31], v[208:211], v[152:155]
    s_waitcnt lgkmcnt(9)
    ds_read_b64_tr_b16 v[26:27], v7 offset:384
    v_exp_f32 v233, v233
    v_mfma_f32_16x16x32_bf16 v[124:127], v[32:35], v[184:187], 0
    ds_read_b64_tr_b16 v[28:29], v7 offset:640
    v_fma_f32 v218, v218, s30, v8
    v_fma_f32 v219, v219, s30, v8
    v_mfma_f32_16x16x32_bf16 v[124:127], v[36:39], v[192:195], v[124:127]
    ds_read_b64_tr_b16 v[30:31], v7 offset:896
    v_exp_f32 v218, v218
    v_mfma_f32_16x16x32_bf16 v[156:159], v[32:35], v[200:203], 0
    ds_read_b64_tr_b16 v[32:33], v7 offset:160
    v_cvt_pk_bf16_f32 v232, v232, v233
    v_exp_f32 v219, v219
    v_mfma_f32_16x16x32_bf16 v[156:159], v[36:39], v[208:211], v[156:159]
    s_waitcnt lgkmcnt(9)
    ds_read_b64_tr_b16 v[34:35], v7 offset:416
    v_fma_f32 v234, v234, s30, v9
    v_mfma_f32_16x16x32_bf16 v[128:131], v[40:43], v[184:187], 0
    ds_read_b64_tr_b16 v[36:37], v7 offset:672
    s_add_u32 m0, s32, 59136
    s_add_u32 s34, s36, 57344
    buffer_load_dwordx4 v1, s[16:19], s34 offen nt lds
    v_mfma_f32_16x16x32_bf16 v[128:131], v[44:47], v[192:195], v[128:131]
    s_setprio 0
    ds_read_b64_tr_b16 v[38:39], v7 offset:928
    v_fma_f32 v235, v235, s30, v9
    v_exp_f32 v234, v234
    v_mfma_f32_16x16x32_bf16 v[160:163], v[40:43], v[200:203], 0
    ds_read_b64_tr_b16 v[40:41], v7 offset:192
    v_cvt_pk_bf16_f32 v217, v218, v219
    v_mfma_f32_16x16x32_bf16 v[160:163], v[44:47], v[208:211], v[160:163]
    s_waitcnt lgkmcnt(9)
    ds_read_b64_tr_b16 v[42:43], v7 offset:448
    v_exp_f32 v235, v235
    v_mfma_f32_16x16x32_bf16 v[132:135], v[48:51], v[184:187], 0
    ds_read_b64_tr_b16 v[44:45], v7 offset:704
    v_fma_f32 v220, v220, s30, v8
    v_fma_f32 v221, v221, s30, v8
    v_mfma_f32_16x16x32_bf16 v[132:135], v[52:55], v[192:195], v[132:135]
    ds_read_b64_tr_b16 v[46:47], v7 offset:960
    v_exp_f32 v220, v220
    v_mfma_f32_16x16x32_bf16 v[164:167], v[48:51], v[200:203], 0
    ds_read_b64_tr_b16 v[48:49], v7 offset:224
    v_cvt_pk_bf16_f32 v233, v234, v235
    v_mfma_f32_16x16x32_bf16 v[164:167], v[52:55], v[208:211], v[164:167]
    s_waitcnt lgkmcnt(9)
    ds_read_b64_tr_b16 v[50:51], v7 offset:480
    v_exp_f32 v221, v221
    v_mfma_f32_16x16x32_bf16 v[136:139], v[24:27], v[184:187], 0
    ds_read_b64_tr_b16 v[52:53], v7 offset:736
    v_fma_f32 v236, v236, s30, v9
    v_fma_f32 v237, v237, s30, v9
    v_mfma_f32_16x16x32_bf16 v[136:139], v[28:31], v[192:195], v[136:139]
    ds_read_b64_tr_b16 v[54:55], v7 offset:992
    v_exp_f32 v236, v236
    v_mfma_f32_16x16x32_bf16 v[168:171], v[24:27], v[200:203], 0
    s_setprio 3
    s_waitcnt vmcnt(6)
    v_add_u32 v7, 84480, v2
    s_barrier
    ds_read_b128 v[24:27], v7 offset:0
    v_cvt_pk_bf16_f32 v218, v220, v221
    v_exp_f32 v237, v237
    v_mfma_f32_16x16x32_bf16 v[168:171], v[28:31], v[208:211], v[168:171]
    s_waitcnt lgkmcnt(9)
    ds_read_b128 v[28:31], v7 offset:64
    v_fma_f32 v222, v222, s30, v8
    v_mfma_f32_16x16x32_bf16 v[140:143], v[32:35], v[184:187], 0
    v_fma_f32 v223, v223, s30, v8
    v_exp_f32 v222, v222
    v_mfma_f32_16x16x32_bf16 v[140:143], v[36:39], v[192:195], v[140:143]
    v_cvt_pk_bf16_f32 v234, v236, v237
    v_exp_f32 v223, v223
    v_mfma_f32_16x16x32_bf16 v[172:175], v[32:35], v[200:203], 0
    ds_read_b128 v[32:35], v7 offset:128
    v_fma_f32 v238, v238, s30, v9
    v_fma_f32 v239, v239, s30, v9
    v_mfma_f32_16x16x32_bf16 v[172:175], v[36:39], v[208:211], v[172:175]
    s_waitcnt lgkmcnt(7)
    ds_read_b128 v[36:39], v7 offset:192
    v_exp_f32 v238, v238
    v_mfma_f32_16x16x32_bf16 v[144:147], v[40:43], v[184:187], 0
    v_cvt_pk_bf16_f32 v219, v222, v223
    v_exp_f32 v239, v239
    v_mfma_f32_16x16x32_bf16 v[144:147], v[44:47], v[192:195], v[144:147]
    v_fma_f32 v224, v224, s30, v8
    v_fma_f32 v225, v225, s30, v8
    v_exp_f32 v224, v224
    v_mfma_f32_16x16x32_bf16 v[176:179], v[40:43], v[200:203], 0
    ds_read_b128 v[40:43], v7 offset:256
    v_cvt_pk_bf16_f32 v235, v238, v239
    v_mfma_f32_16x16x32_bf16 v[176:179], v[44:47], v[208:211], v[176:179]
    s_waitcnt lgkmcnt(5)
    s_setprio 2
    ds_read_b128 v[44:47], v7 offset:320
    v_exp_f32 v225, v225
    v_mfma_f32_16x16x32_bf16 v[148:151], v[48:51], v[184:187], 0
    v_fma_f32 v240, v240, s30, v9
    v_fma_f32 v241, v241, s30, v9
    v_exp_f32 v240, v240
    v_mfma_f32_16x16x32_bf16 v[148:151], v[52:55], v[192:195], v[148:151]
    v_cvt_pk_bf16_f32 v224, v224, v225
    v_exp_f32 v241, v241
    v_mfma_f32_16x16x32_bf16 v[180:183], v[48:51], v[200:203], 0
    ds_read_b128 v[48:51], v7 offset:384
    v_fma_f32 v226, v226, s30, v8
    v_mfma_f32_16x16x32_bf16 v[180:183], v[52:55], v[208:211], v[180:183]
    ds_read_b128 v[52:55], v7 offset:448
    v_fma_f32 v227, v227, s30, v8
    v_exp_f32 v226, v226
    v_cvt_pk_bf16_f32 v240, v240, v241
    v_exp_f32 v227, v227
    s_waitcnt lgkmcnt(7)
    v_mfma_f32_16x16x32_bf16 v[184:187], v[24:27], v[56:59], 0
    s_waitcnt lgkmcnt(6)
    v_fma_f32 v242, v242, s30, v9
    v_fma_f32 v243, v243, s30, v9
    v_exp_f32 v242, v242
    v_mfma_f32_16x16x32_bf16 v[184:187], v[28:31], v[60:63], v[184:187]
    s_waitcnt lgkmcnt(5)
    v_cvt_pk_bf16_f32 v225, v226, v227
    v_mfma_f32_16x16x32_bf16 v[184:187], v[32:35], v[64:67], v[184:187]
    s_waitcnt lgkmcnt(4)
    v_exp_f32 v243, v243
    v_fma_f32 v228, v228, s30, v8
    v_mfma_f32_16x16x32_bf16 v[184:187], v[36:39], v[68:71], v[184:187]
    v_fma_f32 v229, v229, s30, v8
    v_exp_f32 v228, v228
    v_mfma_f32_16x16x32_bf16 v[200:203], v[24:27], v[72:75], 0
    s_setprio 1
    ds_read_b128 v[24:27], v7 offset:512
    v_cvt_pk_bf16_f32 v241, v242, v243
    v_mfma_f32_16x16x32_bf16 v[200:203], v[28:31], v[76:79], v[200:203]
    ds_read_b128 v[28:31], v7 offset:576
    v_exp_f32 v229, v229
    v_mfma_f32_16x16x32_bf16 v[200:203], v[32:35], v[80:83], v[200:203]
    ds_read_b128 v[32:35], v7 offset:640
    v_fma_f32 v244, v244, s30, v9
    v_mfma_f32_16x16x32_bf16 v[200:203], v[36:39], v[84:87], v[200:203]
    s_waitcnt lgkmcnt(6)
    ds_read_b128 v[36:39], v7 offset:704
    v_fma_f32 v245, v245, s30, v9
    v_mfma_f32_16x16x32_bf16 v[188:191], v[40:43], v[56:59], 0
    s_waitcnt lgkmcnt(6)
    v_max_f32 v14, v184, v185
    v_max3_f32 v14, v186, v187, v14
    v_exp_f32 v244, v244
    v_mfma_f32_16x16x32_bf16 v[188:191], v[44:47], v[60:63], v[188:191]
    s_waitcnt lgkmcnt(5)
    v_cvt_pk_bf16_f32 v226, v228, v229
    v_mfma_f32_16x16x32_bf16 v[188:191], v[48:51], v[64:67], v[188:191]
    s_waitcnt lgkmcnt(4)
    v_exp_f32 v245, v245
    v_fma_f32 v230, v230, s30, v8
    v_mfma_f32_16x16x32_bf16 v[188:191], v[52:55], v[68:71], v[188:191]
    v_fma_f32 v231, v231, s30, v8
    v_exp_f32 v230, v230
    v_mfma_f32_16x16x32_bf16 v[204:207], v[40:43], v[72:75], 0
    s_setprio 0
    ds_read_b128 v[40:43], v7 offset:768
    s_add_u32 m0, s32, 67584
    s_add_u32 s34, s36, 32768
    buffer_load_dwordx4 v1, s[20:23], s34 offen nt lds
    v_mfma_f32_16x16x32_bf16 v[204:207], v[44:47], v[76:79], v[204:207]
    ds_read_b128 v[44:47], v7 offset:832
    v_mfma_f32_16x16x32_bf16 v[204:207], v[48:51], v[80:83], v[204:207]
    ds_read_b128 v[48:51], v7 offset:896
    v_max_f32 v15, v200, v201
    v_max3_f32 v15, v202, v203, v15
    v_mfma_f32_16x16x32_bf16 v[204:207], v[52:55], v[84:87], v[204:207]
    s_waitcnt lgkmcnt(6)
    ds_read_b128 v[52:55], v7 offset:960
    v_cvt_pk_bf16_f32 v242, v244, v245
    v_mfma_f32_16x16x32_bf16 v[192:195], v[24:27], v[56:59], 0
    s_waitcnt lgkmcnt(6)
    v_max3_f32 v14, v188, v189, v14
    v_max3_f32 v14, v190, v191, v14
    v_exp_f32 v231, v231
    v_mfma_f32_16x16x32_bf16 v[192:195], v[28:31], v[60:63], v[192:195]
    s_waitcnt lgkmcnt(5)
    v_fma_f32 v246, v246, s30, v9
    v_mfma_f32_16x16x32_bf16 v[192:195], v[32:35], v[64:67], v[192:195]
    s_waitcnt lgkmcnt(4)
    v_fma_f32 v247, v247, s30, v9
    v_exp_f32 v246, v246
    v_mfma_f32_16x16x32_bf16 v[192:195], v[36:39], v[68:71], v[192:195]
    v_cvt_pk_bf16_f32 v227, v230, v231
    v_exp_f32 v247, v247
    v_mfma_f32_16x16x32_bf16 v[208:211], v[24:27], v[72:75], 0
    s_setprio 3
    s_waitcnt vmcnt(5)
    v_add_u32 v7, 101376, v3
    s_barrier
    ds_read_b64_tr_b16 v[24:25], v7 offset:0
    v_max3_f32 v15, v204, v205, v15
    v_mfma_f32_16x16x32_bf16 v[208:211], v[28:31], v[76:79], v[208:211]
    ds_read_b64_tr_b16 v[26:27], v7 offset:256
    v_max3_f32 v15, v206, v207, v15
    v_mfma_f32_16x16x32_bf16 v[208:211], v[32:35], v[80:83], v[208:211]
    ds_read_b64_tr_b16 v[28:29], v7 offset:512
    v_cvt_pk_bf16_f32 v243, v246, v247
    v_mfma_f32_16x16x32_bf16 v[208:211], v[36:39], v[84:87], v[208:211]
    s_waitcnt lgkmcnt(6)
    ds_read_b64_tr_b16 v[30:31], v7 offset:768
    v_mfma_f32_16x16x32_bf16 v[196:199], v[40:43], v[56:59], 0
    s_waitcnt lgkmcnt(6)
    ds_read_b64_tr_b16 v[32:33], v7 offset:32
    v_max3_f32 v14, v192, v193, v14
    v_max3_f32 v14, v194, v195, v14
    v_mfma_f32_16x16x32_bf16 v[196:199], v[44:47], v[60:63], v[196:199]
    s_waitcnt lgkmcnt(6)
    ds_read_b64_tr_b16 v[34:35], v7 offset:288
    s_add_u32 m0, s32, 76032
    s_add_u32 s34, s36, 40960
    buffer_load_dwordx4 v1, s[20:23], s34 offen nt lds
    v_mfma_f32_16x16x32_bf16 v[196:199], v[48:51], v[64:67], v[196:199]
    s_waitcnt lgkmcnt(6)
    ds_read_b64_tr_b16 v[36:37], v7 offset:544
    v_mfma_f32_16x16x32_bf16 v[196:199], v[52:55], v[68:71], v[196:199]
    ds_read_b64_tr_b16 v[38:39], v7 offset:800
    v_mfma_f32_16x16x32_bf16 v[212:215], v[40:43], v[72:75], 0
    s_setprio 2
    ds_read_b64_tr_b16 v[40:41], v7 offset:64
    v_max3_f32 v15, v208, v209, v15
    v_max3_f32 v15, v210, v211, v15
    v_mfma_f32_16x16x32_bf16 v[212:215], v[44:47], v[76:79], v[212:215]
    ds_read_b64_tr_b16 v[42:43], v7 offset:320
    v_mfma_f32_16x16x32_bf16 v[212:215], v[48:51], v[80:83], v[212:215]
    ds_read_b64_tr_b16 v[44:45], v7 offset:576
    v_mfma_f32_16x16x32_bf16 v[212:215], v[52:55], v[84:87], v[212:215]
    ds_read_b64_tr_b16 v[46:47], v7 offset:832
    s_cmp_eq_u32 s29, 0
    s_cbranch_scc1 L_nr8
    s_call_b64 s[40:41], L_rescale
L_nr8:
    v_mfma_f32_16x16x32_bf16 v[248:251], v[20:23], v[216:219], v[248:251]
    ds_read_b64_tr_b16 v[48:49], v7 offset:96
    v_max3_f32 v14, v196, v197, v14
    v_max3_f32 v14, v198, v199, v14
    v_mfma_f32_16x16x32_bf16 v[248:251], v[20:23], v[224:227], v[248:251]
    ds_read_b64_tr_b16 v[50:51], v7 offset:352
    v_max3_f32 v15, v212, v213, v15
    v_max3_f32 v15, v214, v215, v15
    v_mfma_f32_16x16x32_bf16 v[252:255], v[20:23], v[232:235], v[252:255]
    ds_read_b64_tr_b16 v[52:53], v7 offset:608
    v_cmp_gt_f32 vcc, v14, v10
    v_cmp_gt_f32 s[42:43], v15, v11
    s_nop 3
    s_or_b64 s[42:43], s[42:43], vcc
    s_cbranch_scc0 L_nr9
    s_call_b64 s[40:41], L_newmax
L_nr9:
    v_fma_f32 v184, v184, s30, v8
    v_fma_f32 v185, v185, s30, v8
    v_mfma_f32_16x16x32_bf16 v[252:255], v[20:23], v[240:243], v[252:255]
    s_waitcnt lgkmcnt(11)
    ds_read_b64_tr_b16 v[54:55], v7 offset:864
    v_exp_f32 v184, v184
    v_mfma_f32_16x16x32_bf16 v[120:123], v[24:27], v[216:219], v[120:123]
    s_setprio 1
    v_exp_f32 v185, v185
    v_fma_f32 v200, v200, s30, v9
    v_mfma_f32_16x16x32_bf16 v[120:123], v[28:31], v[224:227], v[120:123]
    v_fma_f32 v201, v201, s30, v9
    v_exp_f32 v200, v200
    v_mfma_f32_16x16x32_bf16 v[152:155], v[24:27], v[232:235], v[152:155]
    ds_read_b64_tr_b16 v[24:25], v7 offset:128
    s_add_u32 s34, s38, 2048
    buffer_store_dwordx4 v[96:99], v1, s[24:27], s34 offen nt
    v_mfma_f32_16x16x32_bf16 v[152:155], v[28:31], v[240:243], v[152:155]
    s_waitcnt lgkmcnt(9)
    ds_read_b64_tr_b16 v[26:27], v7 offset:384
    v_cvt_pk_bf16_f32 v184, v184, v185
    v_exp_f32 v201, v201
    v_mfma_f32_16x16x32_bf16 v[124:127], v[32:35], v[216:219], v[124:127]
    ds_read_b64_tr_b16 v[28:29], v7 offset:640
    v_fma_f32 v186, v186, s30, v8
    v_mfma_f32_16x16x32_bf16 v[124:127], v[36:39], v[224:227], v[124:127]
    ds_read_b64_tr_b16 v[30:31], v7 offset:896
    v_fma_f32 v187, v187, s30, v8
    v_exp_f32 v186, v186
    v_mfma_f32_16x16x32_bf16 v[156:159], v[32:35], v[232:235], v[156:159]
    ds_read_b64_tr_b16 v[32:33], v7 offset:160
    v_cvt_pk_bf16_f32 v200, v200, v201
    v_mfma_f32_16x16x32_bf16 v[156:159], v[36:39], v[240:243], v[156:159]
    s_waitcnt lgkmcnt(9)
    ds_read_b64_tr_b16 v[34:35], v7 offset:416
    v_exp_f32 v187, v187
    v_mfma_f32_16x16x32_bf16 v[128:131], v[40:43], v[216:219], v[128:131]
    ds_read_b64_tr_b16 v[36:37], v7 offset:672
    s_add_u32 m0, s32, 0
    s_add_u32 s34, s36, 49152
    buffer_load_dwordx4 v1, s[20:23], s34 offen nt lds
    v_mfma_f32_16x16x32_bf16 v[128:131], v[44:47], v[224:227], v[128:131]
    s_setprio 0
    ds_read_b64_tr_b16 v[38:39], v7 offset:928
    v_fma_f32 v202, v202, s30, v9
    v_fma_f32 v203, v203, s30, v9
    v_mfma_f32_16x16x32_bf16 v[160:163], v[40:43], v[232:235], v[160:163]
    ds_read_b64_tr_b16 v[40:41], v7 offset:192
    v_exp_f32 v202, v202
    v_mfma_f32_16x16x32_bf16 v[160:163], v[44:47], v[240:243], v[160:163]
    s_waitcnt lgkmcnt(9)
    ds_read_b64_tr_b16 v[42:43], v7 offset:448
    v_cvt_pk_bf16_f32 v185, v186, v187
    v_exp_f32 v203, v203
    v_mfma_f32_16x16x32_bf16 v[132:135], v[48:51], v[216:219], v[132:135]
    ds_read_b64_tr_b16 v[44:45], v7 offset:704
    v_fma_f32 v188, v188, s30, v8
    v_mfma_f32_16x16x32_bf16 v[132:135], v[52:55], v[224:227], v[132:135]
    ds_read_b64_tr_b16 v[46:47], v7 offset:960
    v_fma_f32 v189, v189, s30, v8
    v_exp_f32 v188, v188
    v_mfma_f32_16x16x32_bf16 v[164:167], v[48:51], v[232:235], v[164:167]
    ds_read_b64_tr_b16 v[48:49], v7 offset:224
    v_cvt_pk_bf16_f32 v201, v202, v203
    v_exp_f32 v189, v189
    v_mfma_f32_16x16x32_bf16 v[164:167], v[52:55], v[240:243], v[164:167]
    s_waitcnt lgkmcnt(9)
    ds_read_b64_tr_b16 v[50:51], v7 offset:480
    v_fma_f32 v204, v204, s30, v9
    v_mfma_f32_16x16x32_bf16 v[136:139], v[24:27], v[216:219], v[136:139]
    ds_read_b64_tr_b16 v[52:53], v7 offset:736
    v_fma_f32 v205, v205, s30, v9
    v_exp_f32 v204, v204
    v_mfma_f32_16x16x32_bf16 v[136:139], v[28:31], v[224:227], v[136:139]
    ds_read_b64_tr_b16 v[54:55], v7 offset:992
    v_cvt_pk_bf16_f32 v186, v188, v189
    v_mfma_f32_16x16x32_bf16 v[168:171], v[24:27], v[232:235], v[168:171]
    s_setprio 3
    s_waitcnt vmcnt(4)
    v_add_u32 v7, 118272, v2
    s_barrier
    ds_read_b128 v[24:27], v7 offset:0
    v_exp_f32 v205, v205
    v_mfma_f32_16x16x32_bf16 v[168:171], v[28:31], v[240:243], v[168:171]
    s_waitcnt lgkmcnt(9)
    ds_read_b128 v[28:31], v7 offset:64
    v_fma_f32 v190, v190, s30, v8
    v_fma_f32 v191, v191, s30, v8
    v_mfma_f32_16x16x32_bf16 v[140:143], v[32:35], v[216:219], v[140:143]
    v_exp_f32 v190, v190
    v_cvt_pk_bf16_f32 v202, v204, v205
    v_mfma_f32_16x16x32_bf16 v[140:143], v[36:39], v[224:227], v[140:143]
    s_add_u32 m0, s32, 8448
    s_add_u32 s34, s36, 57344
    buffer_load_dwordx4 v1, s[20:23], s34 offen nt lds
    v_exp_f32 v191, v191
    v_mfma_f32_16x16x32_bf16 v[172:175], v[32:35], v[232:235], v[172:175]
    ds_read_b128 v[32:35], v7 offset:128
    v_fma_f32 v206, v206, s30, v9
    v_mfma_f32_16x16x32_bf16 v[172:175], v[36:39], v[240:243], v[172:175]
    s_waitcnt lgkmcnt(7)
    ds_read_b128 v[36:39], v7 offset:192
    v_fma_f32 v207, v207, s30, v9
    v_exp_f32 v206, v206
    v_mfma_f32_16x16x32_bf16 v[144:147], v[40:43], v[216:219], v[144:147]
    v_cvt_pk_bf16_f32 v187, v190, v191
    v_exp_f32 v207, v207
    v_mfma_f32_16x16x32_bf16 v[144:147], v[44:47], v[224:227], v[144:147]
    v_fma_f32 v192, v192, s30, v8
    v_fma_f32 v193, v193, s30, v8
    v_mfma_f32_16x16x32_bf16 v[176:179], v[40:43], v[232:235], v[176:179]
    ds_read_b128 v[40:43], v7 offset:256
    v_exp_f32 v192, v192
    v_mfma_f32_16x16x32_bf16 v[176:179], v[44:47], v[240:243], v[176:179]
    s_waitcnt lgkmcnt(5)
    s_setprio 2
    ds_read_b128 v[44:47], v7 offset:320
    v_cvt_pk_bf16_f32 v203, v206, v207
    v_exp_f32 v193, v193
    v_mfma_f32_16x16x32_bf16 v[148:151], v[48:51], v[216:219], v[148:151]
    v_fma_f32 v208, v208, s30, v9
    v_fma_f32 v209, v209, s30, v9
    v_exp_f32 v208, v208
    v_mfma_f32_16x16x32_bf16 v[148:151], v[52:55], v[224:227], v[148:151]
    v_cvt_pk_bf16_f32 v192, v192, v193
    v_exp_f32 v209, v209
    v_mfma_f32_16x16x32_bf16 v[180:183], v[48:51], v[232:235], v[180:183]
    ds_read_b128 v[48:51], v7 offset:384
    v_fma_f32 v194, v194, s30, v8
    v_mfma_f32_16x16x32_bf16 v[180:183], v[52:55], v[240:243], v[180:183]
    ds_read_b128 v[52:55], v7 offset:448
    v_fma_f32 v195, v195, s30, v8
    v_exp_f32 v194, v194
    v_cvt_pk_bf16_f32 v208, v208, v209
    v_exp_f32 v195, v195
    s_waitcnt lgkmcnt(7)
    v_mfma_f32_16x16x32_bf16 v[216:219], v[24:27], v[56:59], 0
    s_waitcnt lgkmcnt(6)
    v_fma_f32 v210, v210, s30, v9
    v_fma_f32 v211, v211, s30, v9
    v_exp_f32 v210, v210
    v_mfma_f32_16x16x32_bf16 v[216:219], v[28:31], v[60:63], v[216:219]
    s_waitcnt lgkmcnt(5)
    v_cvt_pk_bf16_f32 v193, v194, v195
    v_mfma_f32_16x16x32_bf16 v[216:219], v[32:35], v[64:67], v[216:219]
    s_waitcnt lgkmcnt(4)
    v_exp_f32 v211, v211
    v_fma_f32 v196, v196, s30, v8
    v_mfma_f32_16x16x32_bf16 v[216:219], v[36:39], v[68:71], v[216:219]
    v_fma_f32 v197, v197, s30, v8
    v_exp_f32 v196, v196
    v_mfma_f32_16x16x32_bf16 v[232:235], v[24:27], v[72:75], 0
    s_setprio 1
    ds_read_b128 v[24:27], v7 offset:512
    v_cvt_pk_bf16_f32 v209, v210, v211
    v_mfma_f32_16x16x32_bf16 v[232:235], v[28:31], v[76:79], v[232:235]
    ds_read_b128 v[28:31], v7 offset:576
    v_exp_f32 v197, v197
    v_mfma_f32_16x16x32_bf16 v[232:235], v[32:35], v[80:83], v[232:235]
    ds_read_b128 v[32:35], v7 offset:640
    s_add_u32 s34, s38, 3072
    buffer_store_dwordx4 v[100:103], v1, s[24:27], s34 offen nt
    v_mfma_f32_16x16x32_bf16 v[232:235], v[36:39], v[84:87], v[232:235]
    s_waitcnt lgkmcnt(6)
    ds_read_b128 v[36:39], v7 offset:704
    v_mfma_f32_16x16x32_bf16 v[220:223], v[40:43], v[56:59], 0
    s_waitcnt lgkmcnt(6)
    v_max_f32 v14, v216, v217
    v_max3_f32 v14, v218, v219, v14
    v_mfma_f32_16x16x32_bf16 v[220:223], v[44:47], v[60:63], v[220:223]
    s_waitcnt lgkmcnt(5)
    v_fma_f32 v212, v212, s30, v9
    v_fma_f32 v213, v213, s30, v9
    v_exp_f32 v212, v212
    v_mfma_f32_16x16x32_bf16 v[220:223], v[48:51], v[64:67], v[220:223]
    s_waitcnt lgkmcnt(4)
    v_cvt_pk_bf16_f32 v194, v196, v197
    v_mfma_f32_16x16x32_bf16 v[220:223], v[52:55], v[68:71], v[220:223]
    v_exp_f32 v213, v213
    v_fma_f32 v198, v198, s30, v8
    v_mfma_f32_16x16x32_bf16 v[236:239], v[40:43], v[72:75], 0
    s_setprio 0
    ds_read_b128 v[40:43], v7 offset:768
    v_max_f32 v15, v232, v233
    v_max3_f32 v15, v234, v235, v15
    v_mfma_f32_16x16x32_bf16 v[236:239], v[44:47], v[76:79], v[236:239]
    ds_read_b128 v[44:47], v7 offset:832
    v_fma_f32 v199, v199, s30, v8
    v_mfma_f32_16x16x32_bf16 v[236:239], v[48:51], v[80:83], v[236:239]
    ds_read_b128 v[48:51], v7 offset:896
    v_exp_f32 v198, v198
    v_mfma_f32_16x16x32_bf16 v[236:239], v[52:55], v[84:87], v[236:239]
    s_waitcnt lgkmcnt(6)
    ds_read_b128 v[52:55], v7 offset:960
    v_cvt_pk_bf16_f32 v210, v212, v213
    v_mfma_f32_16x16x32_bf16 v[224:227], v[24:27], v[56:59], 0
    s_waitcnt lgkmcnt(6)
    v_max3_f32 v14, v220, v221, v14
    v_max3_f32 v14, v222, v223, v14
    v_exp_f32 v199, v199
    v_mfma_f32_16x16x32_bf16 v[224:227], v[28:31], v[60:63], v[224:227]
    s_waitcnt lgkmcnt(5)
    v_fma_f32 v214, v214, s30, v9
    v_mfma_f32_16x16x32_bf16 v[224:227], v[32:35], v[64:67], v[224:227]
    s_waitcnt lgkmcnt(4)
    v_fma_f32 v215, v215, s30, v9
    v_exp_f32 v214, v214
    v_mfma_f32_16x16x32_bf16 v[224:227], v[36:39], v[68:71], v[224:227]
    v_cvt_pk_bf16_f32 v195, v198, v199
    v_exp_f32 v215, v215
    v_mfma_f32_16x16x32_bf16 v[240:243], v[24:27], v[72:75], 0
    s_setprio 3
    s_waitcnt vmcnt(4)
    v_add_u32 v7, 135168, v3
    s_barrier
    ds_read_b64_tr_b16 v[24:25], v7 offset:0
    s_add_u32 s34, s38, 4096
    buffer_store_dwordx4 v[104:107], v1, s[24:27], s34 offen nt
    v_mfma_f32_16x16x32_bf16 v[240:243], v[28:31], v[76:79], v[240:243]
    ds_read_b64_tr_b16 v[26:27], v7 offset:256
    v_mfma_f32_16x16x32_bf16 v[240:243], v[32:35], v[80:83], v[240:243]
    ds_read_b64_tr_b16 v[28:29], v7 offset:512
    v_max3_f32 v15, v236, v237, v15
    v_mfma_f32_16x16x32_bf16 v[240:243], v[36:39], v[84:87], v[240:243]
    s_waitcnt lgkmcnt(6)
    ds_read_b64_tr_b16 v[30:31], v7 offset:768
    v_max3_f32 v15, v238, v239, v15
    v_cvt_pk_bf16_f32 v211, v214, v215
    v_mfma_f32_16x16x32_bf16 v[228:231], v[40:43], v[56:59], 0
    s_waitcnt lgkmcnt(6)
    ds_read_b64_tr_b16 v[32:33], v7 offset:32
    v_max3_f32 v14, v224, v225, v14
    v_mfma_f32_16x16x32_bf16 v[228:231], v[44:47], v[60:63], v[228:231]
    s_waitcnt lgkmcnt(6)
    ds_read_b64_tr_b16 v[34:35], v7 offset:288
    v_max3_f32 v14, v226, v227, v14
    v_mfma_f32_16x16x32_bf16 v[228:231], v[48:51], v[64:67], v[228:231]
    s_waitcnt lgkmcnt(6)
    ds_read_b64_tr_b16 v[36:37], v7 offset:544
    v_mfma_f32_16x16x32_bf16 v[228:231], v[52:55], v[68:71], v[228:231]
    ds_read_b64_tr_b16 v[38:39], v7 offset:800
    v_mfma_f32_16x16x32_bf16 v[244:247], v[40:43], v[72:75], 0
    s_setprio 2
    ds_read_b64_tr_b16 v[40:41], v7 offset:64
    v_max3_f32 v15, v240, v241, v15
    v_max3_f32 v15, v242, v243, v15
    v_mfma_f32_16x16x32_bf16 v[244:247], v[44:47], v[76:79], v[244:247]
    ds_read_b64_tr_b16 v[42:43], v7 offset:320
    v_mfma_f32_16x16x32_bf16 v[244:247], v[48:51], v[80:83], v[244:247]
    ds_read_b64_tr_b16 v[44:45], v7 offset:576
    v_mfma_f32_16x16x32_bf16 v[244:247], v[52:55], v[84:87], v[244:247]
    ds_read_b64_tr_b16 v[46:47], v7 offset:832
    s_cmp_eq_u32 s29, 0
    s_cbranch_scc1 L_nr10
    s_call_b64 s[40:41], L_rescale
L_nr10:
    v_mfma_f32_16x16x32_bf16 v[248:251], v[20:23], v[184:187], v[248:251]
    ds_read_b64_tr_b16 v[48:49], v7 offset:96
    v_max3_f32 v14, v228, v229, v14
    v_max3_f32 v14, v230, v231, v14
    v_max3_f32 v15, v244, v245, v15
    v_mfma_f32_16x16x32_bf16 v[248:251], v[20:23], v[192:195], v[248:251]
    ds_read_b64_tr_b16 v[50:51], v7 offset:352
    v_max3_f32 v15, v246, v247, v15
    v_cmp_gt_f32 vcc, v14, v10
    v_cmp_gt_f32 s[42:43], v15, v11
    s_nop 3
    s_or_b64 s[42:43], s[42:43], vcc
    s_cbranch_scc0 L_nr11
    s_call_b64 s[40:41], L_newmax
L_nr11:
    v_fma_f32 v216, v216, s30, v8
    v_fma_f32 v217, v217, s30, v8
    v_mfma_f32_16x16x32_bf16 v[252:255], v[20:23], v[200:203], v[252:255]
    ds_read_b64_tr_b16 v[52:53], v7 offset:608
    v_exp_f32 v216, v216
    v_exp_f32 v217, v217
    v_mfma_f32_16x16x32_bf16 v[252:255], v[20:23], v[208:211], v[252:255]
    s_waitcnt lgkmcnt(11)
    ds_read_b64_tr_b16 v[54:55], v7 offset:864
    v_fma_f32 v232, v232, s30, v9
    v_fma_f32 v233, v233, s30, v9
    v_exp_f32 v232, v232
    v_mfma_f32_16x16x32_bf16 v[120:123], v[24:27], v[184:187], v[120:123]
    s_setprio 1
    v_cvt_pk_bf16_f32 v216, v216, v217
    v_exp_f32 v233, v233
    v_mfma_f32_16x16x32_bf16 v[120:123], v[28:31], v[192:195], v[120:123]
    v_fma_f32 v218, v218, s30, v8
    v_fma_f32 v219, v219, s30, v8
    v_exp_f32 v218, v218
    v_cvt_pk_bf16_f32 v232, v232, v233
    v_mfma_f32_16x16x32_bf16 v[152:155], v[24:27], v[200:203], v[152:155]
    ds_read_b64_tr_b16 v[24:25], v7 offset:128
    s_add_u32 s34, s38, 5120
    buffer_store_dwordx4 v[108:111], v1, s[24:27], s34 offen nt
    v_mfma_f32_16x16x32_bf16 v[152:155], v[28:31], v[208:211], v[152:155]
    s_waitcnt lgkmcnt(9)
    ds_read_b64_tr_b16 v[26:27], v7 offset:384
    v_exp_f32 v219, v219
    v_fma_f32 v234, v234, s30, v9
    v_fma_f32 v235, v235, s30, v9
    v_mfma_f32_16x16x32_bf16 v[124:127], v[32:35], v[184:187], v[124:127]
    ds_read_b64_tr_b16 v[28:29], v7 offset:640
    v_exp_f32 v234, v234
    v_cvt_pk_bf16_f32 v217, v218, v219
    v_mfma_f32_16x16x32_bf16 v[124:127], v[36:39], v[192:195], v[124:127]
    ds_read_b64_tr_b16 v[30:31], v7 offset:896
    v_exp_f32 v235, v235
    v_fma_f32 v220, v220, s30, v8
    v_mfma_f32_16x16x32_bf16 v[156:159], v[32:35], v[200:203], v[156:159]
    ds_read_b64_tr_b16 v[32:33], v7 offset:160
    v_fma_f32 v221, v221, s30, v8
    v_exp_f32 v220, v220
    v_cvt_pk_bf16_f32 v233, v234, v235
    v_mfma_f32_16x16x32_bf16 v[156:159], v[36:39], v[208:211], v[156:159]
    s_waitcnt lgkmcnt(9)
    ds_read_b64_tr_b16 v[34:35], v7 offset:416
    v_exp_f32 v221, v221
    v_fma_f32 v236, v236, s30, v9
    v_mfma_f32_16x16x32_bf16 v[128:131], v[40:43], v[184:187], v[128:131]
    ds_read_b64_tr_b16 v[36:37], v7 offset:672
    v_fma_f32 v237, v237, s30, v9
    v_exp_f32 v236, v236
    v_mfma_f32_16x16x32_bf16 v[128:131], v[44:47], v[192:195], v[128:131]
    s_setprio 0
    ds_read_b64_tr_b16 v[38:39], v7 offset:928
    v_cvt_pk_bf16_f32 v218, v220, v221
    v_exp_f32 v237, v237
    v_fma_f32 v222, v222, s30, v8
    v_mfma_f32_16x16x32_bf16 v[160:163], v[40:43], v[200:203], v[160:163]
    ds_read_b64_tr_b16 v[40:41], v7 offset:192
    v_fma_f32 v223, v223, s30, v8
    v_exp_f32 v222, v222
    v_mfma_f32_16x16x32_bf16 v[160:163], v[44:47], v[208:211], v[160:163]
    s_waitcnt lgkmcnt(9)
    ds_read_b64_tr_b16 v[42:43], v7 offset:448
    v_cvt_pk_bf16_f32 v234, v236, v237
    v_exp_f32 v223, v223
    v_mfma_f32_16x16x32_bf16 v[132:135], v[48:51], v[184:187], v[132:135]
    ds_read_b64_tr_b16 v[44:45], v7 offset:704
    s_add_u32 s34, s38, 6144
    buffer_store_dwordx4 v[112:115], v1, s[24:27], s34 offen nt
    v_fma_f32 v238, v238, s30, v9
    v_mfma_f32_16x16x32_bf16 v[132:135], v[52:55], v[192:195], v[132:135]
    ds_read_b64_tr_b16 v[46:47], v7 offset:960
    v_fma_f32 v239, v239, s30, v9
    v_exp_f32 v238, v238
    v_cvt_pk_bf16_f32 v219, v222, v223
    v_mfma_f32_16x16x32_bf16 v[164:167], v[48:51], v[200:203], v[164:167]
    ds_read_b64_tr_b16 v[48:49], v7 offset:224
    v_exp_f32 v239, v239
    v_fma_f32 v224, v224, s30, v8
    v_mfma_f32_16x16x32_bf16 v[164:167], v[52:55], v[208:211], v[164:167]
    s_waitcnt lgkmcnt(9)
    ds_read_b64_tr_b16 v[50:51], v7 offset:480
    v_fma_f32 v225, v225, s30, v8
    v_exp_f32 v224, v224
    v_mfma_f32_16x16x32_bf16 v[136:139], v[24:27], v[184:187], v[136:139]
    ds_read_b64_tr_b16 v[52:53], v7 offset:736
    v_cvt_pk_bf16_f32 v235, v238, v239
    v_exp_f32 v225, v225
    v_fma_f32 v240, v240, s30, v9
    v_mfma_f32_16x16x32_bf16 v[136:139], v[28:31], v[192:195], v[136:139]
    ds_read_b64_tr_b16 v[54:55], v7 offset:992
    v_fma_f32 v241, v241, s30, v9
    v_exp_f32 v240, v240
    v_mfma_f32_16x16x32_bf16 v[168:171], v[24:27], v[200:203], v[168:171]
    s_setprio 3
    s_waitcnt vmcnt(4)
    v_add_u32 v7, 67584, v3
    s_barrier
    ds_read_b64_tr_b16 v[24:25], v7 offset:0
    v_cvt_pk_bf16_f32 v224, v224, v225
    v_exp_f32 v241, v241
    v_mfma_f32_16x16x32_bf16 v[168:171], v[28:31], v[208:211], v[168:171]
    s_waitcnt lgkmcnt(9)
    ds_read_b64_tr_b16 v[26:27], v7 offset:256
    v_fma_f32 v226, v226, s30, v8
    v_fma_f32 v227, v227, s30, v8
    v_exp_f32 v226, v226
    v_mfma_f32_16x16x32_bf16 v[140:143], v[32:35], v[184:187], v[140:143]
    ds_read_b64_tr_b16 v[28:29], v7 offset:512
    v_cvt_pk_bf16_f32 v240, v240, v241
    v_exp_f32 v227, v227
    v_mfma_f32_16x16x32_bf16 v[140:143], v[36:39], v[192:195], v[140:143]
    ds_read_b64_tr_b16 v[30:31], v7 offset:768
    v_fma_f32 v242, v242, s30, v9
    v_fma_f32 v243, v243, s30, v9
    v_exp_f32 v242, v242
    v_mfma_f32_16x16x32_bf16 v[172:175], v[32:35], v[200:203], v[172:175]
    ds_read_b64_tr_b16 v[32:33], v7 offset:32
    s_add_u32 s34, s38, 7168
    buffer_store_dwordx4 v[116:119], v1, s[24:27], s34 offen nt
    v_mfma_f32_16x16x32_bf16 v[172:175], v[36:39], v[208:211], v[172:175]
    s_waitcnt lgkmcnt(9)
    ds_read_b64_tr_b16 v[34:35], v7 offset:288
    v_cvt_pk_bf16_f32 v225, v226, v227
    v_exp_f32 v243, v243
    v_fma_f32 v228, v228, s30, v8
    v_mfma_f32_16x16x32_bf16 v[144:147], v[40:43], v[184:187], v[144:147]
    ds_read_b64_tr_b16 v[36:37], v7 offset:544
    v_fma_f32 v229, v229, s30, v8
    v_exp_f32 v228, v228
    v_mfma_f32_16x16x32_bf16 v[144:147], v[44:47], v[192:195], v[144:147]
    ds_read_b64_tr_b16 v[38:39], v7 offset:800
    v_cvt_pk_bf16_f32 v241, v242, v243
    v_exp_f32 v229, v229
    v_mfma_f32_16x16x32_bf16 v[176:179], v[40:43], v[200:203], v[176:179]
    ds_read_b64_tr_b16 v[40:41], v7 offset:64
    v_fma_f32 v244, v244, s30, v9
    v_fma_f32 v245, v245, s30, v9
    v_exp_f32 v244, v244
    v_mfma_f32_16x16x32_bf16 v[176:179], v[44:47], v[208:211], v[176:179]
    s_waitcnt lgkmcnt(9)
    s_setprio 2
    ds_read_b64_tr_b16 v[42:43], v7 offset:320
    v_cvt_pk_bf16_f32 v226, v228, v229
    v_exp_f32 v245, v245
    v_mfma_f32_16x16x32_bf16 v[148:151], v[48:51], v[184:187], v[148:151]
    ds_read_b64_tr_b16 v[44:45], v7 offset:576
    v_fma_f32 v230, v230, s30, v8
    v_fma_f32 v231, v231, s30, v8
    v_exp_f32 v230, v230
    v_mfma_f32_16x16x32_bf16 v[148:151], v[52:55], v[192:195], v[148:151]
    ds_read_b64_tr_b16 v[46:47], v7 offset:832
    v_cvt_pk_bf16_f32 v242, v244, v245
    v_exp_f32 v231, v231
    v_mfma_f32_16x16x32_bf16 v[180:183], v[48:51], v[200:203], v[180:183]
    ds_read_b64_tr_b16 v[48:49], v7 offset:96
    v_fma_f32 v246, v246, s30, v9
    v_fma_f32 v247, v247, s30, v9
    v_exp_f32 v246, v246
    v_mfma_f32_16x16x32_bf16 v[180:183], v[52:55], v[208:211], v[180:183]
    ds_read_b64_tr_b16 v[50:51], v7 offset:352
    v_cvt_pk_bf16_f32 v227, v230, v231
    v_exp_f32 v247, v247
    s_nop 0
    v_cvt_pk_bf16_f32 v243, v246, v247
    s_cmp_eq_u32 s29, 0
    s_cbranch_scc1 L_nr12
    s_call_b64 s[40:41], L_rescale
L_nr12:
    v_mfma_f32_16x16x32_bf16 v[248:251], v[20:23], v[216:219], v[248:251]
    ds_read_b64_tr_b16 v[52:53], v7 offset:608
    v_lshrrev_b32 v2, 9, v1
    v_mul_u32_u24 v2, 16, v2
    v_and_b32 v4, 0x3f80, v1
    v_mfma_f32_16x16x32_bf16 v[248:251], v[20:23], v[224:227], v[248:251]
    ds_read_b64_tr_b16 v[54:55], v7 offset:864
    v_add_u32 v4, v4, v1
    v_add3_u32 v2, v2, v4, s37
    v_mfma_f32_16x16x32_bf16 v[252:255], v[20:23], v[232:235], v[252:255]
    v_mfma_f32_16x16x32_bf16 v[252:255], v[20:23], v[240:243], v[252:255]
    s_waitcnt lgkmcnt(12)
    v_mfma_f32_16x16x32_bf16 v[120:123], v[24:27], v[216:219], v[120:123]
    s_setprio 1
    v_rcp_f32 v16, v248
    v_mfma_f32_16x16x32_bf16 v[120:123], v[28:31], v[224:227], v[120:123]
    v_mfma_f32_16x16x32_bf16 v[152:155], v[24:27], v[232:235], v[152:155]
    ds_read_b64_tr_b16 v[24:25], v7 offset:128
    s_nop 0
    v_rcp_f32 v17, v252
    v_mfma_f32_16x16x32_bf16 v[152:155], v[28:31], v[240:243], v[152:155]
    s_waitcnt lgkmcnt(9)
    ds_read_b64_tr_b16 v[26:27], v7 offset:384
    v_mfma_f32_16x16x32_bf16 v[124:127], v[32:35], v[216:219], v[124:127]
    ds_read_b64_tr_b16 v[28:29], v7 offset:640
    v_mul_f32 v120, v120, v16
    v_mul_f32 v121, v121, v16
    v_mul_f32 v122, v122, v16
    v_mul_f32 v123, v123, v16
    v_cvt_pk_bf16_f32 v120, v120, v121
    v_cvt_pk_bf16_f32 v121, v122, v123
    ds_write_b64 v5, v[120:121] offset:0
    v_mfma_f32_16x16x32_bf16 v[124:127], v[36:39], v[224:227], v[124:127]
    ds_read_b64_tr_b16 v[30:31], v7 offset:896
    v_mfma_f32_16x16x32_bf16 v[156:159], v[32:35], v[232:235], v[156:159]
    ds_read_b64_tr_b16 v[32:33], v7 offset:160
    v_mul_f32 v152, v152, v17
    v_mul_f32 v153, v153, v17
    v_mul_f32 v154, v154, v17
    v_mul_f32 v155, v155, v17
    v_cvt_pk_bf16_f32 v152, v152, v153
    v_cvt_pk_bf16_f32 v153, v154, v155
    ds_write_b64 v5, v[152:153] offset:512
    v_mfma_f32_16x16x32_bf16 v[156:159], v[36:39], v[240:243], v[156:159]
    s_waitcnt lgkmcnt(11)
    ds_read_b64_tr_b16 v[34:35], v7 offset:416
    v_mfma_f32_16x16x32_bf16 v[128:131], v[40:43], v[216:219], v[128:131]
    ds_read_b64_tr_b16 v[36:37], v7 offset:672
    v_mul_f32 v124, v124, v16
    v_mul_f32 v125, v125, v16
    v_mul_f32 v126, v126, v16
    v_mul_f32 v127, v127, v16
    v_cvt_pk_bf16_f32 v124, v124, v125
    v_cvt_pk_bf16_f32 v125, v126, v127
    ds_write_b64 v5, v[124:125] offset:32
    v_mfma_f32_16x16x32_bf16 v[128:131], v[44:47], v[224:227], v[128:131]
    s_setprio 0
    ds_read_b64_tr_b16 v[38:39], v7 offset:928
    v_mfma_f32_16x16x32_bf16 v[160:163], v[40:43], v[232:235], v[160:163]
    ds_read_b64_tr_b16 v[40:41], v7 offset:192
    v_mul_f32 v156, v156, v17
    v_mul_f32 v157, v157, v17
    v_mul_f32 v158, v158, v17
    v_mul_f32 v159, v159, v17
    v_cvt_pk_bf16_f32 v156, v156, v157
    v_cvt_pk_bf16_f32 v157, v158, v159
    ds_write_b64 v5, v[156:157] offset:544
    v_mfma_f32_16x16x32_bf16 v[160:163], v[44:47], v[240:243], v[160:163]
    s_waitcnt lgkmcnt(13)
    ds_read_b64_tr_b16 v[42:43], v7 offset:448
    v_mfma_f32_16x16x32_bf16 v[132:135], v[48:51], v[216:219], v[132:135]
    ds_read_b64_tr_b16 v[44:45], v7 offset:704
    v_mul_f32 v128, v128, v16
    v_mul_f32 v129, v129, v16
    v_mul_f32 v130, v130, v16
    v_mul_f32 v131, v131, v16
    v_cvt_pk_bf16_f32 v128, v128, v129
    v_cvt_pk_bf16_f32 v129, v130, v131
    ds_write_b64 v5, v[128:129] offset:64
    v_mfma_f32_16x16x32_bf16 v[132:135], v[52:55], v[224:227], v[132:135]
    ds_read_b64_tr_b16 v[46:47], v7 offset:960
    v_mfma_f32_16x16x32_bf16 v[164:167], v[48:51], v[232:235], v[164:167]
    ds_read_b64_tr_b16 v[48:49], v7 offset:224
    v_mul_f32 v160, v160, v17
    v_mul_f32 v161, v161, v17
    v_mul_f32 v162, v162, v17
    v_mul_f32 v163, v163, v17
    v_cvt_pk_bf16_f32 v160, v160, v161
    v_cvt_pk_bf16_f32 v161, v162, v163
    ds_write_b64 v5, v[160:161] offset:576
    v_mfma_f32_16x16x32_bf16 v[164:167], v[52:55], v[240:243], v[164:167]
    s_waitcnt lgkmcnt(14)
    ds_read_b64_tr_b16 v[50:51], v7 offset:480
    v_mfma_f32_16x16x32_bf16 v[136:139], v[24:27], v[216:219], v[136:139]
    ds_read_b64_tr_b16 v[52:53], v7 offset:736
    v_mul_f32 v132, v132, v16
    v_mul_f32 v133, v133, v16
    v_mul_f32 v134, v134, v16
    v_mul_f32 v135, v135, v16
    v_cvt_pk_bf16_f32 v132, v132, v133
    v_cvt_pk_bf16_f32 v133, v134, v135
    ds_write_b64 v5, v[132:133] offset:96
    v_mfma_f32_16x16x32_bf16 v[136:139], v[28:31], v[224:227], v[136:139]
    ds_read_b64_tr_b16 v[54:55], v7 offset:992
    v_mfma_f32_16x16x32_bf16 v[168:171], v[24:27], v[232:235], v[168:171]
    s_setprio 3
    v_mul_f32 v164, v164, v17
    v_mul_f32 v165, v165, v17
    v_mul_f32 v166, v166, v17
    v_mul_f32 v167, v167, v17
    v_cvt_pk_bf16_f32 v164, v164, v165
    v_cvt_pk_bf16_f32 v165, v166, v167
    ds_write_b64 v5, v[164:165] offset:608
    s_waitcnt lgkmcnt(0)
    ds_read_b128 v[184:187], v2 offset:0
    ds_read_b128 v[188:191], v2 offset:2080
    ds_read_b128 v[192:195], v2 offset:4160
    ds_read_b128 v[196:199], v2 offset:6240
    v_mfma_f32_16x16x32_bf16 v[168:171], v[28:31], v[240:243], v[168:171]
    v_mfma_f32_16x16x32_bf16 v[140:143], v[32:35], v[216:219], v[140:143]
    v_mul_f32 v136, v136, v16
    v_mul_f32 v137, v137, v16
    v_mul_f32 v138, v138, v16
    v_mul_f32 v139, v139, v16
    v_cvt_pk_bf16_f32 v136, v136, v137
    v_cvt_pk_bf16_f32 v137, v138, v139
    ds_write_b64 v5, v[136:137] offset:128
    v_mfma_f32_16x16x32_bf16 v[140:143], v[36:39], v[224:227], v[140:143]
    v_mfma_f32_16x16x32_bf16 v[172:175], v[32:35], v[232:235], v[172:175]
    v_mul_f32 v168, v168, v17
    v_mul_f32 v169, v169, v17
    v_mul_f32 v170, v170, v17
    v_mul_f32 v171, v171, v17
    v_cvt_pk_bf16_f32 v168, v168, v169
    v_cvt_pk_bf16_f32 v169, v170, v171
    ds_write_b64 v5, v[168:169] offset:640
    s_waitcnt lgkmcnt(5)
    s_add_u32 s34, s39, 0
    buffer_store_dwordx4 v[184:187], v4, s[24:27], s34 offen nt
    v_mfma_f32_16x16x32_bf16 v[172:175], v[36:39], v[240:243], v[172:175]
    v_mfma_f32_16x16x32_bf16 v[144:147], v[40:43], v[216:219], v[144:147]
    v_mul_f32 v140, v140, v16
    v_mul_f32 v141, v141, v16
    v_mul_f32 v142, v142, v16
    v_mul_f32 v143, v143, v16
    v_cvt_pk_bf16_f32 v140, v140, v141
    v_cvt_pk_bf16_f32 v141, v142, v143
    ds_write_b64 v5, v[140:141] offset:160
    v_mfma_f32_16x16x32_bf16 v[144:147], v[44:47], v[224:227], v[144:147]
    v_mfma_f32_16x16x32_bf16 v[176:179], v[40:43], v[232:235], v[176:179]
    v_mul_f32 v172, v172, v17
    v_mul_f32 v173, v173, v17
    v_mul_f32 v174, v174, v17
    v_mul_f32 v175, v175, v17
    v_cvt_pk_bf16_f32 v172, v172, v173
    v_cvt_pk_bf16_f32 v173, v174, v175
    ds_write_b64 v5, v[172:173] offset:672
    s_waitcnt lgkmcnt(6)
    s_add_u32 s34, s39, 2048
    buffer_store_dwordx4 v[188:191], v4, s[24:27], s34 offen nt
    v_mfma_f32_16x16x32_bf16 v[176:179], v[44:47], v[240:243], v[176:179]
    s_setprio 2
    v_mfma_f32_16x16x32_bf16 v[148:151], v[48:51], v[216:219], v[148:151]
    v_mul_f32 v144, v144, v16
    v_mul_f32 v145, v145, v16
    v_mul_f32 v146, v146, v16
    v_mul_f32 v147, v147, v16
    v_cvt_pk_bf16_f32 v144, v144, v145
    v_cvt_pk_bf16_f32 v145, v146, v147
    ds_write_b64 v5, v[144:145] offset:192
    v_mfma_f32_16x16x32_bf16 v[148:151], v[52:55], v[224:227], v[148:151]
    v_mfma_f32_16x16x32_bf16 v[180:183], v[48:51], v[232:235], v[180:183]
    v_mul_f32 v176, v176, v17
    v_mul_f32 v177, v177, v17
    v_mul_f32 v178, v178, v17
    v_mul_f32 v179, v179, v17
    v_cvt_pk_bf16_f32 v176, v176, v177
    v_cvt_pk_bf16_f32 v177, v178, v179
    ds_write_b64 v5, v[176:177] offset:704
    s_waitcnt lgkmcnt(7)
    s_add_u32 s34, s39, 4096
    buffer_store_dwordx4 v[192:195], v4, s[24:27], s34 offen nt
    s_waitcnt lgkmcnt(6)
    s_add_u32 s34, s39, 6144
    buffer_store_dwordx4 v[196:199], v4, s[24:27], s34 offen nt
    v_mfma_f32_16x16x32_bf16 v[180:183], v[52:55], v[240:243], v[180:183]
    v_mul_f32 v148, v148, v16
    v_mul_f32 v149, v149, v16
    v_mul_f32 v150, v150, v16
    v_mul_f32 v151, v151, v16
    v_cvt_pk_bf16_f32 v148, v148, v149
    v_cvt_pk_bf16_f32 v149, v150, v151
    ds_write_b64 v5, v[148:149] offset:224
    s_nop 0
    v_mul_f32 v180, v180, v17
    v_mul_f32 v181, v181, v17
    v_mul_f32 v182, v182, v17
    v_mul_f32 v183, v183, v17
    v_cvt_pk_bf16_f32 v180, v180, v181
    v_cvt_pk_bf16_f32 v181, v182, v183
    ds_write_b64 v5, v[180:181] offset:736
    s_waitcnt lgkmcnt(0)
    ds_read_b128 v[200:203], v2 offset:128
    ds_read_b128 v[204:207], v2 offset:2208
    ds_read_b128 v[208:211], v2 offset:4288
    ds_read_b128 v[212:215], v2 offset:6368
    s_waitcnt lgkmcnt(3)
    s_add_u32 s34, s39, 128
    buffer_store_dwordx4 v[200:203], v4, s[24:27], s34 offen nt
    s_waitcnt lgkmcnt(2)
    s_add_u32 s34, s39, 2176
    buffer_store_dwordx4 v[204:207], v4, s[24:27], s34 offen nt
    s_waitcnt lgkmcnt(1)
    s_add_u32 s34, s39, 4224
    buffer_store_dwordx4 v[208:211], v4, s[24:27], s34 offen nt
    s_waitcnt lgkmcnt(0)
    s_add_u32 s34, s39, 6272
    buffer_store_dwordx4 v[212:215], v4, s[24:27], s34 offen nt
L_end:
    s_endpgm
L_newmax:
    s_nop 4
    v_mov_b32 v12, v14
    s_nop 1
    v_permlane32_swap_b32 v14, v12
    v_max_f32 v14, v14, v12
    v_mov_b32 v12, v14
    s_nop 1
    v_permlane16_swap_b32 v14, v12
    v_max_f32 v14, v14, v12
    v_mul_f32 v12, s31, v14
    v_add_f32 v13, s33, v14
    v_cmp_gt_f32 vcc, v14, v10
    s_nop 2
    v_cndmask_b32 v12, v8, v12, vcc
    v_cndmask_b32 v10, v10, v13, vcc
    v_sub_f32 v18, v12, v8
    v_exp_f32 v18, v18
    v_mov_b32 v8, v12
    v_mov_b32 v12, v15
    s_nop 1
    v_permlane32_swap_b32 v15, v12
    v_max_f32 v15, v15, v12
    v_mov_b32 v12, v15
    s_nop 1
    v_permlane16_swap_b32 v15, v12
    v_max_f32 v15, v15, v12
    v_mul_f32 v12, s31, v15
    v_add_f32 v13, s33, v15
    v_cmp_gt_f32 vcc, v15, v11
    s_nop 2
    v_cndmask_b32 v12, v9, v12, vcc
    v_cndmask_b32 v11, v11, v13, vcc
    v_sub_f32 v19, v12, v9
    v_exp_f32 v19, v19
    v_mov_b32 v9, v12
    s_mov_b32 s29, 1
    s_nop 4
    s_setpc_b64 s[40:41]
L_rescale:
    s_nop 15
    v_mul_f32 v120, v120, v18
    v_mul_f32 v121, v121, v18
    v_mul_f32 v122, v122, v18
    v_mul_f32 v123, v123, v18
    v_mul_f32 v124, v124, v18
    v_mul_f32 v125, v125, v18
    v_mul_f32 v126, v126, v18
    v_mul_f32 v127, v127, v18
    v_mul_f32 v128, v128, v18
    v_mul_f32 v129, v129, v18
    v_mul_f32 v130, v130, v18
    v_mul_f32 v131, v131, v18
    v_mul_f32 v132, v132, v18
    v_mul_f32 v133, v133, v18
    v_mul_f32 v134, v134, v18
    v_mul_f32 v135, v135, v18
    v_mul_f32 v136, v136, v18
    v_mul_f32 v137, v137, v18
    v_mul_f32 v138, v138, v18
    v_mul_f32 v139, v139, v18
    v_mul_f32 v140, v140, v18
    v_mul_f32 v141, v141, v18
    v_mul_f32 v142, v142, v18
    v_mul_f32 v143, v143, v18
    v_mul_f32 v144, v144, v18
    v_mul_f32 v145, v145, v18
    v_mul_f32 v146, v146, v18
    v_mul_f32 v147, v147, v18
    v_mul_f32 v148, v148, v18
    v_mul_f32 v149, v149, v18
    v_mul_f32 v150, v150, v18
    v_mul_f32 v151, v151, v18
    v_mul_f32 v248, v248, v18
    v_mul_f32 v249, v249, v18
    v_mul_f32 v250, v250, v18
    v_mul_f32 v251, v251, v18
    v_mul_f32 v152, v152, v19
    v_mul_f32 v153, v153, v19
    v_mul_f32 v154, v154, v19
    v_mul_f32 v155, v155, v19
    v_mul_f32 v156, v156, v19
    v_mul_f32 v157, v157, v19
    v_mul_f32 v158, v158, v19
    v_mul_f32 v159, v159, v19
    v_mul_f32 v160, v160, v19
    v_mul_f32 v161, v161, v19
    v_mul_f32 v162, v162, v19
    v_mul_f32 v163, v163, v19
    v_mul_f32 v164, v164, v19
    v_mul_f32 v165, v165, v19
    v_mul_f32 v166, v166, v19
    v_mul_f32 v167, v167, v19
    v_mul_f32 v168, v168, v19
    v_mul_f32 v169, v169, v19
    v_mul_f32 v170, v170, v19
    v_mul_f32 v171, v171, v19
    v_mul_f32 v172, v172, v19
    v_mul_f32 v173, v173, v19
    v_mul_f32 v174, v174, v19
    v_mul_f32 v175, v175, v19
    v_mul_f32 v176, v176, v19
    v_mul_f32 v177, v177, v19
    v_mul_f32 v178, v178, v19
    v_mul_f32 v179, v179, v19
    v_mul_f32 v180, v180, v19
    v_mul_f32 v181, v181, v19
    v_mul_f32 v182, v182, v19
    v_mul_f32 v183, v183, v19
    v_mul_f32 v252, v252, v19
    v_mul_f32 v253, v253, v19
    v_mul_f32 v254, v254, v19
    v_mul_f32 v255, v255, v19
    s_mov_b32 s29, 0
    s_nop 4
    s_setpc_b64 s[40:41]

.section .rodata,"a"
.p2align 6
.amdhsa_kernel standalone__mha_softmax__near_ridge_kernel
  .amdhsa_next_free_vgpr 256
  .amdhsa_next_free_sgpr 48
  .amdhsa_accum_offset 256
  .amdhsa_group_segment_fixed_size 0
  .amdhsa_kernarg_size 48
  .amdhsa_user_sgpr_count 2
  .amdhsa_user_sgpr_kernarg_segment_ptr 1
  .amdhsa_system_sgpr_workgroup_id_x 1
.end_amdhsa_kernel
```
